```python
import torch

def _softmax(x, axis=-1):
    return torch.softmax(x, dim=axis)
def _gelu(x):
    return torch.nn.functional.gelu(x, approximate="tanh")
def _silu(x):
    return torch.nn.functional.silu(x)
def _sigmoid(x):
    return torch.sigmoid(x)
def _layernorm(x, axis=-1, eps=1e-5):
    m = x.mean(dim=axis, keepdim=True)
    v = x.var(dim=axis, keepdim=True, unbiased=False)
    return (x - m) / torch.sqrt(v + eps)
def _scatter_add(tgt, idx, src, axis=0):
    return tgt.clone().index_add_(axis, idx, src)
def _segment_sum(src, seg, n):
    out = torch.zeros((n,) + src.shape[1:], dtype=src.dtype)
    return out.index_add_(0, seg, src)
def _pad(x, pw):
    flat = tuple(v for pair in reversed(pw) for v in pair)
    return torch.nn.functional.pad(x, flat)

kernel_name = 'gated_mix__mha_block_cached__glu_gated_swiglu__decode'

def setup_inputs():

    _w = (lambda a: (lambda t: t.to(torch.bfloat16) if t.is_floating_point() else t)(torch.as_tensor(a)))
    def _A_setup():
        B, Sq, D = 1, 1, 640
        H, Sk, Dh = 32, 8192, 192
        return {
            "x": _w((lambda *s: torch.randn(*s, dtype=torch.bfloat16) * 0.05)(B, Sq, D)),
            "k_cache": _w((lambda *s: torch.randn(*s, dtype=torch.bfloat16) * 3.2)(B, H, Sk, Dh)),
            "v_cache": _w((lambda *s: torch.randn(*s, dtype=torch.bfloat16) * 0.2)(B, H, Sk, Dh)),
            "wq": _w((lambda *s: torch.randn(*s, dtype=torch.bfloat16) * 3.2)(D, H * Dh) * (D ** -0.5)),
            "wo": _w((lambda *s: torch.randn(*s, dtype=torch.bfloat16) * 0.2)(H * Dh, D) * ((H * Dh) ** -0.5)),
        }
    _A_in = _A_setup()

    def _B_setup():
        B, S, D, F = 1, 1, 640, 1536
        return {
            "x": _w((lambda *s: torch.randn(*s, dtype=torch.bfloat16) * 0.05)(B, S, D)),
            "w1": _w((lambda *s: torch.randn(*s, dtype=torch.bfloat16) * 0.4)(D, F) * (2.0 / D) ** 0.5),
            "w3": _w((lambda *s: torch.randn(*s, dtype=torch.bfloat16) * 0.4)(D, F) * (2.0 / D) ** 0.5),
            "w2": _w((lambda *s: torch.randn(*s, dtype=torch.bfloat16) * 0.4)(F, D) * (2.0 / F) ** 0.5),
        }
    _B_in = _B_setup()

    return {
        "A_x": _A_in["x"],
        "A_k_cache": _A_in["k_cache"],
        "A_v_cache": _A_in["v_cache"],
        "A_wq": _A_in["wq"],
        "A_wo": _A_in["wo"],
        "B_x": _B_in["x"],
        "B_w1": _B_in["w1"],
        "B_w3": _B_in["w3"],
        "B_w2": _B_in["w2"],
        "gate_w": _w((lambda *s: torch.randn(*s, dtype=torch.bfloat16) * 0.05)(640) * 16.0),
    }

def reference(A_x, A_k_cache, A_v_cache, A_wq, A_wo, B_x, B_w1, B_w3, B_w2, gate_w):
    def _A_ref(x, k_cache, v_cache, wq, wo):
        B, Sq, D = x.shape
        H, Dh = 32, 192
        q = (lambda x, *d: x.permute(*d))((x @ wq).reshape(B, Sq, H, Dh), 0, 2, 1, 3)
        scores = torch.einsum("bhqd,bhkd->bhqk", q, k_cache) * (Dh ** -0.5)
        p = _softmax(scores, axis=-1)
        o = torch.einsum("bhqk,bhkd->bhqd", p, v_cache)
        return (lambda x, *d: x.permute(*d))(o, 0, 2, 1, 3).reshape(B, Sq, H * Dh) @ wo

    def _B_ref(x, w1, w3, w2):
        gate = torch.einsum("bsd,df->bsf", x, w1)
        up = torch.einsum("bsd,df->bsf", x, w3)
        h = _silu(gate) * up
        out = torch.einsum("bsf,fd->bsd", h, w2)
        return out

    x = A_x
    g = _sigmoid((x * gate_w).sum(-1, keepdims=True))
    a = _A_ref(x, A_k_cache, A_v_cache, A_wq, A_wo)
    b = _B_ref(x, B_w1, B_w3, B_w2)
    return g * a + (1 - g) * b
```

```asm
; @launch grid=(256,1,1) block=(512,1,1) lds=19456
.amdgcn_target "amdgcn-amd-amdhsa--gfx950"
.text
.globl gated_mix__mha_block_cached__glu_gated_swiglu__decode_kernel
.p2align 8
.type gated_mix__mha_block_cached__glu_gated_swiglu__decode_kernel,@function
gated_mix__mha_block_cached__glu_gated_swiglu__decode_kernel:
    s_cmp_ge_u32 s2, 256
    s_cbranch_scc1 L_END
    s_load_dwordx16 s[64:79], s[0:1], 0
    s_load_dwordx8 s[80:87], s[0:1], 64
    s_load_dwordx2 s[88:89], s[0:1], 96
    v_lshrrev_b32 v12, 6, v0
    v_and_b32 v0, 63, v0
    v_readfirstlane_b32 s48, v12
    s_and_b32 s52, s2, 7
    s_lshr_b32 s55, s2, 3
    s_and_b32 s56, s55, 3
    s_lshl_b32 s49, s52, 2
    s_add_u32 s49, s49, s56
    s_lshr_b32 s50, s55, 2
    s_mul_i32 s90, s2, 1
    s_and_b32 s90, s90, 15
    s_getreg_b32 s3, hwreg(HW_REG_XCC_ID)
    s_and_b32 s3, s3, 15
    s_add_u32 s3, s3, 1
    s_and_b32 s53, s2, 15
    s_lshr_b32 s54, s2, 4
    s_mul_i32 s51, s49, 3145728
    s_mul_i32 s52, s50, 393216
    s_add_u32 s51, s51, s52
    s_mov_b32 s57, 0x3dd53b95
    v_lshrrev_b32 v12, 3, v0
    v_and_b32 v13, 7, v0
    v_lshlrev_b32 v11, 4, v0
    v_mul_u32_u24 v1, 384, v12
    v_lshl_add_u32 v1, v13, 4, v1
    s_mul_i32 s52, s48, 3072
    v_add_u32 v1, s52, v1
    s_sub_u32 s52, s48, 1
    s_lshl_b32 s55, s52, 4
    s_mul_i32 s56, s50, 80
    s_add_u32 s55, s55, s56
    s_sub_u32 s56, s48, 6
    s_lshl_b32 s56, s56, 4
    s_cmp_eq_u32 s48, 0
    s_cselect_b32 s56, 32, s56
    s_mul_i32 s58, s54, 40
    s_add_u32 s56, s56, s58
    s_mul_i32 s61, s49, 384
    s_and_b32 s62, s53, 7
    s_mul_i32 s62, s62, 384
    s_cmp_lt_u32 s52, 5
    s_cselect_b32 s55, s55, s56
    s_movk_i32 s60, 3072
    s_cselect_b32 s60, 12288, s60
    s_cselect_b32 s61, s61, s62
    s_cselect_b32 s63, 1, 0
    s_mul_i32 s59, s55, s60
    s_add_u32 s59, s59, s61
    v_mul_lo_u32 v2, v12, s60
    v_lshl_add_u32 v2, v13, 4, v2
    v_add_u32 v3, s55, v12
    v_lshlrev_b32 v3, 1, v3
    s_waitcnt lgkmcnt(0)
    s_mov_b32 s4, s64
    s_and_b32 s5, s65, 0xffff
    s_mov_b32 s6, 1280
    s_mov_b32 s7, 0x20000
    s_cmp_lt_u32 s53, 8
    s_cselect_b32 s52, s76, s78
    s_cselect_b32 s55, s77, s79
    s_cmp_eq_u32 s63, 1
    s_cselect_b32 s16, s70, s52
    s_cselect_b32 s17, s71, s55
    s_mov_b32 s18, 1966080
    s_cselect_b32 s18, 7864320, s18
    s_and_b32 s17, s17, 0xffff
    s_mov_b32 s19, 0x20000
    s_mov_b32 s8, s66
    s_and_b32 s9, s67, 0xffff
    s_mov_b32 s10, 100663296
    s_mov_b32 s11, 0x20000
    s_mov_b32 s44, s88
    s_and_b32 s45, s89, 0xffff
    s_mov_b32 s46, 2097152
    s_mov_b32 s47, 0x20000
    s_cmp_eq_u32 s48, 0
    s_cbranch_scc1 L_CTRL
    buffer_load_ushort v56, v3, s[4:7], 0 offen
    buffer_load_ushort v57, v3, s[4:7], 0 offen offset:16
    buffer_load_dwordx4 v[140:143], v2, s[16:19], s59 offen offset:0 nt
    buffer_load_dwordx4 v[144:147], v2, s[16:19], s59 offen offset:128 nt
    buffer_load_dwordx4 v[148:151], v2, s[16:19], s59 offen offset:256 nt
    s_lshl_b32 s55, s60, 3
    s_add_u32 s55, s55, s59
    buffer_load_dwordx4 v[152:155], v2, s[16:19], s55 offen offset:0 nt
    buffer_load_dwordx4 v[156:159], v2, s[16:19], s55 offen offset:128 nt
    buffer_load_dwordx4 v[160:163], v2, s[16:19], s55 offen offset:256 nt
    s_add_u32 s52, s51, 0
    buffer_load_dwordx4 v[164:167], v1, s[8:11], s52 offen offset:0 nt
    buffer_load_dwordx4 v[168:171], v1, s[8:11], s52 offen offset:128 nt
    buffer_load_dwordx4 v[172:175], v1, s[8:11], s52 offen offset:256 nt
    s_add_u32 s52, s51, 24576
    buffer_load_dwordx4 v[176:179], v1, s[8:11], s52 offen offset:0 nt
    buffer_load_dwordx4 v[180:183], v1, s[8:11], s52 offen offset:128 nt
    buffer_load_dwordx4 v[184:187], v1, s[8:11], s52 offen offset:256 nt
    s_add_u32 s52, s51, 49152
    buffer_load_dwordx4 v[188:191], v1, s[8:11], s52 offen offset:0 nt
    buffer_load_dwordx4 v[192:195], v1, s[8:11], s52 offen offset:128 nt
    buffer_load_dwordx4 v[196:199], v1, s[8:11], s52 offen offset:256 nt
    s_add_u32 s52, s51, 73728
    buffer_load_dwordx4 v[200:203], v1, s[8:11], s52 offen offset:0 nt
    buffer_load_dwordx4 v[204:207], v1, s[8:11], s52 offen offset:128 nt
    buffer_load_dwordx4 v[208:211], v1, s[8:11], s52 offen offset:256 nt
    s_add_u32 s52, s51, 98304
    buffer_load_dwordx4 v[212:215], v1, s[8:11], s52 offen offset:0 nt
    buffer_load_dwordx4 v[216:219], v1, s[8:11], s52 offen offset:128 nt
    buffer_load_dwordx4 v[220:223], v1, s[8:11], s52 offen offset:256 nt
    s_add_u32 s52, s51, 122880
    buffer_load_dwordx4 v[224:227], v1, s[8:11], s52 offen offset:0 nt
    buffer_load_dwordx4 v[228:231], v1, s[8:11], s52 offen offset:128 nt
    buffer_load_dwordx4 v[232:235], v1, s[8:11], s52 offen offset:256 nt
    s_mov_b32 s12, s68
    s_and_b32 s13, s69, 0xffff
    s_mov_b32 s14, 100663296
    s_mov_b32 s15, 0x20000
    s_mov_b32 s20, s72
    s_and_b32 s21, s73, 0xffff
    s_mov_b32 s22, 7864320
    s_mov_b32 s23, 0x20000
    s_mov_b32 s28, s80
    s_and_b32 s29, s81, 0xffff
    s_mov_b32 s30, 1966080
    s_mov_b32 s31, 0x20000
    s_mov_b32 s32, s82
    s_and_b32 s33, s83, 0xffff
    s_mov_b32 s34, 1280
    s_mov_b32 s35, 0x20000
    s_mov_b32 s36, s84
    s_and_b32 s37, s85, 0xffff
    s_mov_b32 s38, 1280
    s_mov_b32 s39, 0x20000
    s_mov_b32 s40, s86
    s_and_b32 s41, s87, 0xffff
    s_mov_b32 s42, 256
    s_mov_b32 s43, 0x20000
    v_lshlrev_b32 v18, 2, v0
    s_mul_i32 s55, s48, 30720
    v_add_u32 v4, s55, v18
    s_mul_i32 s55, s48, 7680
    v_add_u32 v5, s55, v18
    v_mov_b32 v19, 0x40000000
    v_cmp_gt_u32 vcc, 40, v0
    s_nop 1
    v_cndmask_b32 v4, v19, v4, vcc
    v_cndmask_b32 v5, v19, v5, vcc
    v_lshrrev_b32 v18, 4, v0
    v_lshl_add_u32 v18, v18, 3, v13
    v_mul_u32_u24 v10, 24, v18
    s_mul_i32 s55, s48, 768
    v_add_u32 v10, s55, v10
    s_mov_b32 s55, 43691
    v_lshl_add_u32 v14, v0, 2, 0
    v_mul_lo_u32 v15, v14, s55
    v_lshrrev_b32 v15, 18, v15
    v_mul_u32_u24 v16, 6, v15
    v_sub_u32 v16, v14, v16
    v_lshrrev_b32 v17, 3, v15
    v_and_b32 v18, 7, v15
    v_and_b32 v19, 1, v17
    v_lshlrev_b32 v19, 1, v19
    v_lshrrev_b32 v17, 1, v17
    v_add_u32 v19, v19, v17
    v_mul_u32_u24 v19, 6, v19
    v_add_u32 v19, v19, v16
    v_lshrrev_b32 v17, 3, v19
    v_lshlrev_b32 v17, 6, v17
    v_and_b32 v19, 7, v19
    v_add_u32 v19, v19, v17
    v_lshl_add_u32 v6, v18, 3, v19
    v_lshl_add_u32 v14, v0, 2, 1
    v_mul_lo_u32 v15, v14, s55
    v_lshrrev_b32 v15, 18, v15
    v_mul_u32_u24 v16, 6, v15
    v_sub_u32 v16, v14, v16
    v_lshrrev_b32 v17, 3, v15
    v_and_b32 v18, 7, v15
    v_and_b32 v19, 1, v17
    v_lshlrev_b32 v19, 1, v19
    v_lshrrev_b32 v17, 1, v17
    v_add_u32 v19, v19, v17
    v_mul_u32_u24 v19, 6, v19
    v_add_u32 v19, v19, v16
    v_lshrrev_b32 v17, 3, v19
    v_lshlrev_b32 v17, 6, v17
    v_and_b32 v19, 7, v19
    v_add_u32 v19, v19, v17
    v_lshl_add_u32 v7, v18, 3, v19
    v_lshl_add_u32 v14, v0, 2, 2
    v_mul_lo_u32 v15, v14, s55
    v_lshrrev_b32 v15, 18, v15
    v_mul_u32_u24 v16, 6, v15
    v_sub_u32 v16, v14, v16
    v_lshrrev_b32 v17, 3, v15
    v_and_b32 v18, 7, v15
    v_and_b32 v19, 1, v17
    v_lshlrev_b32 v19, 1, v19
    v_lshrrev_b32 v17, 1, v17
    v_add_u32 v19, v19, v17
    v_mul_u32_u24 v19, 6, v19
    v_add_u32 v19, v19, v16
    v_lshrrev_b32 v17, 3, v19
    v_lshlrev_b32 v17, 6, v17
    v_and_b32 v19, 7, v19
    v_add_u32 v19, v19, v17
    v_lshl_add_u32 v8, v18, 3, v19
    v_lshl_add_u32 v14, v0, 2, 3
    v_mul_lo_u32 v15, v14, s55
    v_lshrrev_b32 v15, 18, v15
    v_mul_u32_u24 v16, 6, v15
    v_sub_u32 v16, v14, v16
    v_lshrrev_b32 v17, 3, v15
    v_and_b32 v18, 7, v15
    v_and_b32 v19, 1, v17
    v_lshlrev_b32 v19, 1, v19
    v_lshrrev_b32 v17, 1, v17
    v_add_u32 v19, v19, v17
    v_mul_u32_u24 v19, 6, v19
    v_add_u32 v19, v19, v16
    v_lshrrev_b32 v17, 3, v19
    v_lshlrev_b32 v17, 6, v17
    v_and_b32 v19, 7, v19
    v_add_u32 v19, v19, v17
    v_lshl_add_u32 v9, v18, 3, v19
    v_mov_b32 v20, 0
    v_mov_b32 v21, 0
    v_mov_b32 v22, 0
    v_mov_b32 v23, 0
    v_mov_b32 v24, 0
    v_mov_b32 v25, 0
    v_mov_b32 v26, 0
    v_mov_b32 v27, 0
    v_mov_b32 v28, 0
    v_mov_b32 v29, 0
    v_mov_b32 v30, 0
    v_mov_b32 v31, 0
    v_mov_b32 v32, 0
    v_mov_b32 v33, 0
    v_mov_b32 v34, 0
    v_mov_b32 v35, 0
    v_mov_b32 v36, 0
    v_mov_b32 v37, 0
    v_mov_b32 v38, 0
    v_mov_b32 v39, 0
    v_mov_b32 v40, 0
    v_mov_b32 v41, 0
    v_mov_b32 v42, 0
    v_mov_b32 v43, 0
    v_mov_b32 v139, 0
    s_lshl_b32 s61, s49, 13
    s_add_u32 s63, s61, 655360
    s_add_u32 s61, s61, 196608
    s_mul_i32 s62, s50, 20480
    s_add_u32 s62, s62, 458752
    s_cmp_eq_u32 s48, 2
    s_cbranch_scc0 L_G0_SKIP
    v_lshlrev_b32 v18, 2, v0
    buffer_load_dword v106, v18, s[4:7], 0 offen offset:0
    buffer_load_dword v111, v18, s[32:35], 0 offen offset:0
    buffer_load_dword v107, v18, s[4:7], 0 offen offset:256
    buffer_load_dword v112, v18, s[32:35], 0 offen offset:256
    buffer_load_dword v108, v18, s[4:7], 0 offen offset:512
    buffer_load_dword v113, v18, s[32:35], 0 offen offset:512
    buffer_load_dword v109, v18, s[4:7], 0 offen offset:768
    buffer_load_dword v114, v18, s[32:35], 0 offen offset:768
    buffer_load_dword v110, v18, s[4:7], 0 offen offset:1024
    buffer_load_dword v115, v18, s[32:35], 0 offen offset:1024
L_G0_SKIP:
    s_nop 4
    s_waitcnt vmcnt(21)
    v_lshlrev_b32 v102, 16, v56
    v_dot2c_f32_bf16 v20, v140, v56
    v_dot2c_f32_bf16 v22, v141, v56
    v_dot2c_f32_bf16 v24, v142, v56
    v_dot2c_f32_bf16 v26, v143, v56
    v_dot2c_f32_bf16 v28, v144, v56
    v_dot2c_f32_bf16 v30, v145, v56
    v_dot2c_f32_bf16 v32, v146, v56
    v_dot2c_f32_bf16 v34, v147, v56
    v_dot2c_f32_bf16 v36, v148, v56
    v_dot2c_f32_bf16 v38, v149, v56
    v_dot2c_f32_bf16 v40, v150, v56
    v_dot2c_f32_bf16 v42, v151, v56
    v_dot2c_f32_bf16 v21, v140, v102
    v_dot2c_f32_bf16 v23, v141, v102
    v_dot2c_f32_bf16 v25, v142, v102
    v_dot2c_f32_bf16 v27, v143, v102
    v_dot2c_f32_bf16 v29, v144, v102
    v_dot2c_f32_bf16 v31, v145, v102
    v_dot2c_f32_bf16 v33, v146, v102
    v_dot2c_f32_bf16 v35, v147, v102
    v_dot2c_f32_bf16 v37, v148, v102
    v_dot2c_f32_bf16 v39, v149, v102
    v_dot2c_f32_bf16 v41, v150, v102
    v_dot2c_f32_bf16 v43, v151, v102
    s_add_u32 s52, s51, 147456
    buffer_load_dwordx4 v[140:143], v1, s[8:11], s52 offen offset:0 nt
    buffer_load_dwordx4 v[144:147], v1, s[8:11], s52 offen offset:128 nt
    buffer_load_dwordx4 v[148:151], v1, s[8:11], s52 offen offset:256 nt
    s_waitcnt vmcnt(21)
    v_lshlrev_b32 v102, 16, v57
    v_dot2c_f32_bf16 v20, v152, v57
    v_dot2c_f32_bf16 v22, v153, v57
    v_dot2c_f32_bf16 v24, v154, v57
    v_dot2c_f32_bf16 v26, v155, v57
    v_dot2c_f32_bf16 v28, v156, v57
    v_dot2c_f32_bf16 v30, v157, v57
    v_dot2c_f32_bf16 v32, v158, v57
    v_dot2c_f32_bf16 v34, v159, v57
    v_dot2c_f32_bf16 v36, v160, v57
    v_dot2c_f32_bf16 v38, v161, v57
    v_dot2c_f32_bf16 v40, v162, v57
    v_dot2c_f32_bf16 v42, v163, v57
    v_dot2c_f32_bf16 v21, v152, v102
    v_dot2c_f32_bf16 v23, v153, v102
    v_dot2c_f32_bf16 v25, v154, v102
    v_dot2c_f32_bf16 v27, v155, v102
    v_dot2c_f32_bf16 v29, v156, v102
    v_dot2c_f32_bf16 v31, v157, v102
    v_dot2c_f32_bf16 v33, v158, v102
    v_dot2c_f32_bf16 v35, v159, v102
    v_dot2c_f32_bf16 v37, v160, v102
    v_dot2c_f32_bf16 v39, v161, v102
    v_dot2c_f32_bf16 v41, v162, v102
    v_dot2c_f32_bf16 v43, v163, v102
    s_add_u32 s52, s51, 172032
    buffer_load_dwordx4 v[152:155], v1, s[8:11], s52 offen offset:0 nt
    buffer_load_dwordx4 v[156:159], v1, s[8:11], s52 offen offset:128 nt
    buffer_load_dwordx4 v[160:163], v1, s[8:11], s52 offen offset:256 nt
    v_add_f32_dpp v20, v20, v20 row_ror:8 row_mask:0xf bank_mask:0xf
    v_add_f32_dpp v21, v21, v21 row_ror:8 row_mask:0xf bank_mask:0xf
    v_add_f32_dpp v22, v22, v22 row_ror:8 row_mask:0xf bank_mask:0xf
    v_add_f32_dpp v23, v23, v23 row_ror:8 row_mask:0xf bank_mask:0xf
    v_add_f32_dpp v24, v24, v24 row_ror:8 row_mask:0xf bank_mask:0xf
    v_add_f32_dpp v25, v25, v25 row_ror:8 row_mask:0xf bank_mask:0xf
    v_add_f32_dpp v26, v26, v26 row_ror:8 row_mask:0xf bank_mask:0xf
    v_add_f32_dpp v27, v27, v27 row_ror:8 row_mask:0xf bank_mask:0xf
    v_add_f32_dpp v28, v28, v28 row_ror:8 row_mask:0xf bank_mask:0xf
    v_add_f32_dpp v29, v29, v29 row_ror:8 row_mask:0xf bank_mask:0xf
    v_add_f32_dpp v30, v30, v30 row_ror:8 row_mask:0xf bank_mask:0xf
    v_add_f32_dpp v31, v31, v31 row_ror:8 row_mask:0xf bank_mask:0xf
    v_add_f32_dpp v32, v32, v32 row_ror:8 row_mask:0xf bank_mask:0xf
    v_add_f32_dpp v33, v33, v33 row_ror:8 row_mask:0xf bank_mask:0xf
    v_add_f32_dpp v34, v34, v34 row_ror:8 row_mask:0xf bank_mask:0xf
    v_add_f32_dpp v35, v35, v35 row_ror:8 row_mask:0xf bank_mask:0xf
    v_add_f32_dpp v36, v36, v36 row_ror:8 row_mask:0xf bank_mask:0xf
    v_add_f32_dpp v37, v37, v37 row_ror:8 row_mask:0xf bank_mask:0xf
    v_add_f32_dpp v38, v38, v38 row_ror:8 row_mask:0xf bank_mask:0xf
    v_add_f32_dpp v39, v39, v39 row_ror:8 row_mask:0xf bank_mask:0xf
    v_add_f32_dpp v40, v40, v40 row_ror:8 row_mask:0xf bank_mask:0xf
    v_add_f32_dpp v41, v41, v41 row_ror:8 row_mask:0xf bank_mask:0xf
    v_add_f32_dpp v42, v42, v42 row_ror:8 row_mask:0xf bank_mask:0xf
    v_add_f32_dpp v43, v43, v43 row_ror:8 row_mask:0xf bank_mask:0xf
    v_permlane16_swap_b32 v20, v32
    v_permlane16_swap_b32 v21, v33
    v_permlane16_swap_b32 v22, v34
    v_permlane16_swap_b32 v23, v35
    v_permlane16_swap_b32 v24, v36
    v_permlane16_swap_b32 v25, v37
    v_permlane16_swap_b32 v26, v38
    v_permlane16_swap_b32 v27, v39
    v_permlane16_swap_b32 v28, v40
    v_permlane16_swap_b32 v29, v41
    v_permlane16_swap_b32 v30, v42
    v_permlane16_swap_b32 v31, v43
    v_add_f32 v20, v20, v32
    v_add_f32 v21, v21, v33
    v_add_f32 v22, v22, v34
    v_add_f32 v23, v23, v35
    v_add_f32 v24, v24, v36
    v_add_f32 v25, v25, v37
    v_add_f32 v26, v26, v38
    v_add_f32 v27, v27, v39
    v_add_f32 v28, v28, v40
    v_add_f32 v29, v29, v41
    v_add_f32 v30, v30, v42
    v_add_f32 v31, v31, v43
    v_permlane32_swap_b32 v20, v26
    v_permlane32_swap_b32 v21, v27
    v_permlane32_swap_b32 v22, v28
    v_permlane32_swap_b32 v23, v29
    v_permlane32_swap_b32 v24, v30
    v_permlane32_swap_b32 v25, v31
    v_add_f32 v20, v20, v26
    v_add_f32 v21, v21, v27
    v_add_f32 v22, v22, v28
    v_add_f32 v23, v23, v29
    v_add_f32 v24, v24, v30
    v_add_f32 v25, v25, v31
    ds_write_b64 v10, v[20:21] offset:0
    ds_write_b64 v10, v[22:23] offset:8
    ds_write_b64 v10, v[24:25] offset:16
    s_waitcnt lgkmcnt(0)
    s_barrier
    s_cmp_eq_u32 s48, 6
    s_cbranch_scc0 L_PF_SKIP
    s_mov_b32 exec_lo, -1
    s_mov_b32 exec_hi, 0xffff
    ds_read_b128 v[106:109], v11 offset:0
    ds_read_b128 v[110:113], v11 offset:4608
    ds_read_b128 v[114:117], v11 offset:5376
    s_waitcnt lgkmcnt(0)
    v_add_f32 v106, v106, v110
    v_add_f32 v107, v107, v111
    v_add_f32 v108, v108, v112
    v_add_f32 v109, v109, v113
    v_add_f32 v106, v106, v114
    v_add_f32 v107, v107, v115
    v_add_f32 v108, v108, v116
    v_add_f32 v109, v109, v117
    v_mov_b32 v118, 0x7fc00000
    v_cmp_eq_u32 vcc, -1, v106
    s_nop 1
    v_cndmask_b32 v106, v106, v118, vcc
    v_cmp_eq_u32 vcc, -1, v107
    s_nop 1
    v_cndmask_b32 v107, v107, v118, vcc
    v_cmp_eq_u32 vcc, -1, v108
    s_nop 1
    v_cndmask_b32 v108, v108, v118, vcc
    v_cmp_eq_u32 vcc, -1, v109
    s_nop 1
    v_cndmask_b32 v109, v109, v118, vcc
    s_lshl_b32 s55, s53, 4
    s_add_u32 s55, s55, s54
    s_mul_i32 s55, s55, 768
    s_add_u32 s55, s55, 0
    v_lshlrev_b32 v110, 2, v6
    v_lshlrev_b32 v111, 2, v7
    v_lshlrev_b32 v112, 2, v8
    v_lshlrev_b32 v113, 2, v9
    buffer_store_dword v106, v110, s[44:47], s55 offen sc1
    buffer_store_dword v107, v111, s[44:47], s55 offen sc1
    buffer_store_dword v108, v112, s[44:47], s55 offen sc1
    buffer_store_dword v109, v113, s[44:47], s55 offen sc1
    s_mov_b64 exec, -1
L_PF_SKIP:
    s_nop 4
    s_barrier
    s_branch L_JOIN
L_CTRL:
    s_nop 4
    s_lshl_b32 s61, s49, 13
    s_add_u32 s63, s61, 655360
    s_add_u32 s61, s61, 196608
    s_mul_i32 s62, s50, 20480
    s_add_u32 s62, s62, 458752
    s_mov_b32 s40, s86
    s_and_b32 s41, s87, 0xffff
    s_mov_b32 s42, 256
    s_mov_b32 s43, 0x20000
    v_mov_b32 v139, 0
    buffer_load_dword v114, v139, s[40:43], 0 offen sc1
    v_mov_b32 v106, -1
    v_mov_b32 v107, -1
    v_mov_b32 v108, -1
    v_mov_b32 v109, -1
    s_lshl_b32 s55, s50, 10
    s_add_u32 s56, s55, s63
    buffer_store_dwordx4 v[106:109], v11, s[44:47], s56 offen sc1
    s_add_u32 s56, s55, s61
    buffer_store_dwordx4 v[106:109], v11, s[44:47], s56 offen sc1
    s_lshl_b32 s56, s53, 4
    s_add_u32 s56, s56, s54
    s_mul_i32 s56, s56, 768
    s_add_u32 s56, s56, 0
    s_mov_b32 exec_lo, -1
    s_mov_b32 exec_hi, 0xffff
    buffer_store_dwordx4 v[106:109], v11, s[44:47], s56 offen sc1
    s_mov_b32 exec_lo, -1
    s_mov_b32 exec_hi, 0xff
    s_mul_i32 s56, s49, 640
    s_add_u32 s56, s56, s62
    buffer_store_dwordx4 v[106:109], v11, s[44:47], s56 offen sc1
    s_mov_b64 exec, -1
    buffer_load_ushort v56, v3, s[4:7], 0 offen
    buffer_load_ushort v57, v3, s[4:7], 0 offen offset:16
    buffer_load_dwordx4 v[140:143], v2, s[16:19], s59 offen offset:0 nt
    buffer_load_dwordx4 v[144:147], v2, s[16:19], s59 offen offset:128 nt
    buffer_load_dwordx4 v[148:151], v2, s[16:19], s59 offen offset:256 nt
    s_mov_b32 s12, s68
    s_and_b32 s13, s69, 0xffff
    s_mov_b32 s14, 100663296
    s_mov_b32 s15, 0x20000
    s_mov_b32 s20, s72
    s_and_b32 s21, s73, 0xffff
    s_mov_b32 s22, 7864320
    s_mov_b32 s23, 0x20000
    s_mov_b32 s28, s80
    s_and_b32 s29, s81, 0xffff
    s_mov_b32 s30, 1966080
    s_mov_b32 s31, 0x20000
    s_mov_b32 s32, s82
    s_and_b32 s33, s83, 0xffff
    s_mov_b32 s34, 1280
    s_mov_b32 s35, 0x20000
    s_mov_b32 s36, s84
    s_and_b32 s37, s85, 0xffff
    s_mov_b32 s38, 1280
    s_mov_b32 s39, 0x20000
    s_mov_b32 s40, s86
    s_and_b32 s41, s87, 0xffff
    s_mov_b32 s42, 256
    s_mov_b32 s43, 0x20000
    v_lshlrev_b32 v18, 2, v0
    s_mul_i32 s55, s48, 30720
    v_add_u32 v4, s55, v18
    s_mul_i32 s55, s48, 7680
    v_add_u32 v5, s55, v18
    v_mov_b32 v19, 0x40000000
    v_cmp_gt_u32 vcc, 40, v0
    s_nop 1
    v_cndmask_b32 v4, v19, v4, vcc
    v_cndmask_b32 v5, v19, v5, vcc
    v_lshrrev_b32 v18, 4, v0
    v_lshl_add_u32 v18, v18, 3, v13
    v_mul_u32_u24 v10, 24, v18
    s_mul_i32 s55, s48, 768
    v_add_u32 v10, s55, v10
    s_mov_b32 s55, 43691
    v_lshl_add_u32 v14, v0, 2, 0
    v_mul_lo_u32 v15, v14, s55
    v_lshrrev_b32 v15, 18, v15
    v_mul_u32_u24 v16, 6, v15
    v_sub_u32 v16, v14, v16
    v_lshrrev_b32 v17, 3, v15
    v_and_b32 v18, 7, v15
    v_and_b32 v19, 1, v17
    v_lshlrev_b32 v19, 1, v19
    v_lshrrev_b32 v17, 1, v17
    v_add_u32 v19, v19, v17
    v_mul_u32_u24 v19, 6, v19
    v_add_u32 v19, v19, v16
    v_lshrrev_b32 v17, 3, v19
    v_lshlrev_b32 v17, 6, v17
    v_and_b32 v19, 7, v19
    v_add_u32 v19, v19, v17
    v_lshl_add_u32 v6, v18, 3, v19
    v_lshl_add_u32 v14, v0, 2, 1
    v_mul_lo_u32 v15, v14, s55
    v_lshrrev_b32 v15, 18, v15
    v_mul_u32_u24 v16, 6, v15
    v_sub_u32 v16, v14, v16
    v_lshrrev_b32 v17, 3, v15
    v_and_b32 v18, 7, v15
    v_and_b32 v19, 1, v17
    v_lshlrev_b32 v19, 1, v19
    v_lshrrev_b32 v17, 1, v17
    v_add_u32 v19, v19, v17
    v_mul_u32_u24 v19, 6, v19
    v_add_u32 v19, v19, v16
    v_lshrrev_b32 v17, 3, v19
    v_lshlrev_b32 v17, 6, v17
    v_and_b32 v19, 7, v19
    v_add_u32 v19, v19, v17
    v_lshl_add_u32 v7, v18, 3, v19
    v_lshl_add_u32 v14, v0, 2, 2
    v_mul_lo_u32 v15, v14, s55
    v_lshrrev_b32 v15, 18, v15
    v_mul_u32_u24 v16, 6, v15
    v_sub_u32 v16, v14, v16
    v_lshrrev_b32 v17, 3, v15
    v_and_b32 v18, 7, v15
    v_and_b32 v19, 1, v17
    v_lshlrev_b32 v19, 1, v19
    v_lshrrev_b32 v17, 1, v17
    v_add_u32 v19, v19, v17
    v_mul_u32_u24 v19, 6, v19
    v_add_u32 v19, v19, v16
    v_lshrrev_b32 v17, 3, v19
    v_lshlrev_b32 v17, 6, v17
    v_and_b32 v19, 7, v19
    v_add_u32 v19, v19, v17
    v_lshl_add_u32 v8, v18, 3, v19
    v_lshl_add_u32 v14, v0, 2, 3
    v_mul_lo_u32 v15, v14, s55
    v_lshrrev_b32 v15, 18, v15
    v_mul_u32_u24 v16, 6, v15
    v_sub_u32 v16, v14, v16
    v_lshrrev_b32 v17, 3, v15
    v_and_b32 v18, 7, v15
    v_and_b32 v19, 1, v17
    v_lshlrev_b32 v19, 1, v19
    v_lshrrev_b32 v17, 1, v17
    v_add_u32 v19, v19, v17
    v_mul_u32_u24 v19, 6, v19
    v_add_u32 v19, v19, v16
    v_lshrrev_b32 v17, 3, v19
    v_lshlrev_b32 v17, 6, v17
    v_and_b32 v19, 7, v19
    v_add_u32 v19, v19, v17
    v_lshl_add_u32 v9, v18, 3, v19
    v_mov_b32 v20, 0
    v_mov_b32 v21, 0
    v_mov_b32 v22, 0
    v_mov_b32 v23, 0
    v_mov_b32 v24, 0
    v_mov_b32 v25, 0
    v_mov_b32 v26, 0
    v_mov_b32 v27, 0
    v_mov_b32 v28, 0
    v_mov_b32 v29, 0
    v_mov_b32 v30, 0
    v_mov_b32 v31, 0
    v_mov_b32 v32, 0
    v_mov_b32 v33, 0
    v_mov_b32 v34, 0
    v_mov_b32 v35, 0
    v_mov_b32 v36, 0
    v_mov_b32 v37, 0
    v_mov_b32 v38, 0
    v_mov_b32 v39, 0
    v_mov_b32 v40, 0
    v_mov_b32 v41, 0
    v_mov_b32 v42, 0
    v_mov_b32 v43, 0
    v_mov_b32 v139, 0
    s_waitcnt vmcnt(0)
    s_lshl_b32 s55, s49, 3
    s_add_u32 s56, s55, s50
    v_mov_b32 v106, s3
    s_mov_b64 exec, 1
    buffer_store_byte v106, v139, s[40:43], s56 offen sc1
    s_mov_b64 exec, -1
    s_waitcnt vmcnt(1)
    v_lshlrev_b32 v102, 16, v56
    v_dot2c_f32_bf16 v20, v140, v56
    v_dot2c_f32_bf16 v22, v141, v56
    v_dot2c_f32_bf16 v24, v142, v56
    v_dot2c_f32_bf16 v26, v143, v56
    v_dot2c_f32_bf16 v28, v144, v56
    v_dot2c_f32_bf16 v30, v145, v56
    v_dot2c_f32_bf16 v32, v146, v56
    v_dot2c_f32_bf16 v34, v147, v56
    v_dot2c_f32_bf16 v36, v148, v56
    v_dot2c_f32_bf16 v38, v149, v56
    v_dot2c_f32_bf16 v40, v150, v56
    v_dot2c_f32_bf16 v42, v151, v56
    v_dot2c_f32_bf16 v21, v140, v102
    v_dot2c_f32_bf16 v23, v141, v102
    v_dot2c_f32_bf16 v25, v142, v102
    v_dot2c_f32_bf16 v27, v143, v102
    v_dot2c_f32_bf16 v29, v144, v102
    v_dot2c_f32_bf16 v31, v145, v102
    v_dot2c_f32_bf16 v33, v146, v102
    v_dot2c_f32_bf16 v35, v147, v102
    v_dot2c_f32_bf16 v37, v148, v102
    v_dot2c_f32_bf16 v39, v149, v102
    v_dot2c_f32_bf16 v41, v150, v102
    v_dot2c_f32_bf16 v43, v151, v102
    v_add_f32_dpp v20, v20, v20 row_ror:8 row_mask:0xf bank_mask:0xf
    v_add_f32_dpp v21, v21, v21 row_ror:8 row_mask:0xf bank_mask:0xf
    v_add_f32_dpp v22, v22, v22 row_ror:8 row_mask:0xf bank_mask:0xf
    v_add_f32_dpp v23, v23, v23 row_ror:8 row_mask:0xf bank_mask:0xf
    v_add_f32_dpp v24, v24, v24 row_ror:8 row_mask:0xf bank_mask:0xf
    v_add_f32_dpp v25, v25, v25 row_ror:8 row_mask:0xf bank_mask:0xf
    v_add_f32_dpp v26, v26, v26 row_ror:8 row_mask:0xf bank_mask:0xf
    v_add_f32_dpp v27, v27, v27 row_ror:8 row_mask:0xf bank_mask:0xf
    v_add_f32_dpp v28, v28, v28 row_ror:8 row_mask:0xf bank_mask:0xf
    v_add_f32_dpp v29, v29, v29 row_ror:8 row_mask:0xf bank_mask:0xf
    v_add_f32_dpp v30, v30, v30 row_ror:8 row_mask:0xf bank_mask:0xf
    v_add_f32_dpp v31, v31, v31 row_ror:8 row_mask:0xf bank_mask:0xf
    v_add_f32_dpp v32, v32, v32 row_ror:8 row_mask:0xf bank_mask:0xf
    v_add_f32_dpp v33, v33, v33 row_ror:8 row_mask:0xf bank_mask:0xf
    v_add_f32_dpp v34, v34, v34 row_ror:8 row_mask:0xf bank_mask:0xf
    v_add_f32_dpp v35, v35, v35 row_ror:8 row_mask:0xf bank_mask:0xf
    v_add_f32_dpp v36, v36, v36 row_ror:8 row_mask:0xf bank_mask:0xf
    v_add_f32_dpp v37, v37, v37 row_ror:8 row_mask:0xf bank_mask:0xf
    v_add_f32_dpp v38, v38, v38 row_ror:8 row_mask:0xf bank_mask:0xf
    v_add_f32_dpp v39, v39, v39 row_ror:8 row_mask:0xf bank_mask:0xf
    v_add_f32_dpp v40, v40, v40 row_ror:8 row_mask:0xf bank_mask:0xf
    v_add_f32_dpp v41, v41, v41 row_ror:8 row_mask:0xf bank_mask:0xf
    v_add_f32_dpp v42, v42, v42 row_ror:8 row_mask:0xf bank_mask:0xf
    v_add_f32_dpp v43, v43, v43 row_ror:8 row_mask:0xf bank_mask:0xf
    v_permlane16_swap_b32 v20, v32
    v_permlane16_swap_b32 v21, v33
    v_permlane16_swap_b32 v22, v34
    v_permlane16_swap_b32 v23, v35
    v_permlane16_swap_b32 v24, v36
    v_permlane16_swap_b32 v25, v37
    v_permlane16_swap_b32 v26, v38
    v_permlane16_swap_b32 v27, v39
    v_permlane16_swap_b32 v28, v40
    v_permlane16_swap_b32 v29, v41
    v_permlane16_swap_b32 v30, v42
    v_permlane16_swap_b32 v31, v43
    v_add_f32 v20, v20, v32
    v_add_f32 v21, v21, v33
    v_add_f32 v22, v22, v34
    v_add_f32 v23, v23, v35
    v_add_f32 v24, v24, v36
    v_add_f32 v25, v25, v37
    v_add_f32 v26, v26, v38
    v_add_f32 v27, v27, v39
    v_add_f32 v28, v28, v40
    v_add_f32 v29, v29, v41
    v_add_f32 v30, v30, v42
    v_add_f32 v31, v31, v43
    v_permlane32_swap_b32 v20, v26
    v_permlane32_swap_b32 v21, v27
    v_permlane32_swap_b32 v22, v28
    v_permlane32_swap_b32 v23, v29
    v_permlane32_swap_b32 v24, v30
    v_permlane32_swap_b32 v25, v31
    v_add_f32 v20, v20, v26
    v_add_f32 v21, v21, v27
    v_add_f32 v22, v22, v28
    v_add_f32 v23, v23, v29
    v_add_f32 v24, v24, v30
    v_add_f32 v25, v25, v31
    ds_write_b64 v10, v[20:21] offset:0
    ds_write_b64 v10, v[22:23] offset:8
    ds_write_b64 v10, v[24:25] offset:16
    s_waitcnt lgkmcnt(0)
    s_barrier
    s_mov_b32 exec_lo, -1
    s_mov_b32 exec_hi, 0xffff
    ds_read_b128 v[106:109], v11 offset:768
    ds_read_b128 v[110:113], v11 offset:1536
    ds_read_b128 v[114:117], v11 offset:2304
    ds_read_b128 v[118:121], v11 offset:3072
    ds_read_b128 v[122:125], v11 offset:3840
    s_waitcnt lgkmcnt(0)
    v_add_f32 v106, v106, v110
    v_add_f32 v107, v107, v111
    v_add_f32 v108, v108, v112
    v_add_f32 v109, v109, v113
    v_add_f32 v106, v106, v114
    v_add_f32 v107, v107, v115
    v_add_f32 v108, v108, v116
    v_add_f32 v109, v109, v117
    v_add_f32 v106, v106, v118
    v_add_f32 v107, v107, v119
    v_add_f32 v108, v108, v120
    v_add_f32 v109, v109, v121
    v_add_f32 v106, v106, v122
    v_add_f32 v107, v107, v123
    v_add_f32 v108, v108, v124
    v_add_f32 v109, v109, v125
    v_mov_b32 v126, 0x7fc00000
    v_cmp_eq_u32 vcc, -1, v106
    s_nop 1
    v_cndmask_b32 v106, v106, v126, vcc
    v_cmp_eq_u32 vcc, -1, v107
    s_nop 1
    v_cndmask_b32 v107, v107, v126, vcc
    v_cmp_eq_u32 vcc, -1, v108
    s_nop 1
    v_cndmask_b32 v108, v108, v126, vcc
    v_cmp_eq_u32 vcc, -1, v109
    s_nop 1
    v_cndmask_b32 v109, v109, v126, vcc
    s_lshl_b32 s56, s50, 10
    s_add_u32 s56, s56, s63
    s_add_u32 s52, s56, 1048576
    buffer_store_dwordx4 v[106:109], v11, s[44:47], s56 offen sc1
    s_mov_b32 s58, 400000
L_FL_LOOP:
    s_nop 4
    buffer_load_dwordx2 v[12:13], v139, s[40:43], s55 offen sc1
    s_waitcnt vmcnt(0)
    v_readfirstlane_b32 s72, v12
    v_readfirstlane_b32 s73, v13
    s_sub_u32 s74, s72, 0x01010101
    s_andn2_b32 s74, s74, s72
    s_sub_u32 s75, s73, 0x01010101
    s_andn2_b32 s75, s75, s73
    s_or_b32 s56, s74, s75
    s_and_b32 s56, s56, 0x80808080
    s_cmp_eq_u32 s56, 0
    s_cbranch_scc1 L_FL_DONE
    s_sub_u32 s58, s58, 1
    s_cmp_eq_u32 s58, 0
    s_cbranch_scc1 L_FL_DONE
    s_branch L_FL_LOOP
L_FL_DONE:
    s_nop 4
    s_bfe_u32 s56, s72, 0x80000
    s_cmp_eq_u32 s56, s3
    s_cselect_b32 s24, 0, 0
    s_add_u32 s24, s24, 0
    s_add_u32 s64, s24, s63
    s_bfe_u32 s56, s72, 0x80008
    s_cmp_eq_u32 s56, s3
    s_cselect_b32 s25, 0, 0
    s_add_u32 s25, s25, 1024
    s_add_u32 s65, s25, s63
    s_bfe_u32 s56, s72, 0x80010
    s_cmp_eq_u32 s56, s3
    s_cselect_b32 s26, 0, 0
    s_add_u32 s26, s26, 2048
    s_add_u32 s66, s26, s63
    s_bfe_u32 s56, s72, 0x80018
    s_cmp_eq_u32 s56, s3
    s_cselect_b32 s27, 0, 0
    s_add_u32 s27, s27, 3072
    s_add_u32 s67, s27, s63
    s_bfe_u32 s56, s73, 0x80000
    s_cmp_eq_u32 s56, s3
    s_cselect_b32 s32, 0, 0
    s_add_u32 s32, s32, 4096
    s_add_u32 s68, s32, s63
    s_bfe_u32 s56, s73, 0x80008
    s_cmp_eq_u32 s56, s3
    s_cselect_b32 s33, 0, 0
    s_add_u32 s33, s33, 5120
    s_add_u32 s69, s33, s63
    s_bfe_u32 s56, s73, 0x80010
    s_cmp_eq_u32 s56, s3
    s_cselect_b32 s34, 0, 0
    s_add_u32 s34, s34, 6144
    s_add_u32 s70, s34, s63
    s_bfe_u32 s56, s73, 0x80018
    s_cmp_eq_u32 s56, s3
    s_cselect_b32 s35, 0, 0
    s_add_u32 s35, s35, 7168
    s_add_u32 s71, s35, s63
    s_mov_b32 s58, 400000
L_PQ_LOOP:
    s_nop 4
    buffer_load_dwordx4 v[12:15], v11, s[44:47], s64 offen sc1
    buffer_load_dwordx4 v[16:19], v11, s[44:47], s65 offen sc1
    buffer_load_dwordx4 v[20:23], v11, s[44:47], s66 offen sc1
    buffer_load_dwordx4 v[24:27], v11, s[44:47], s67 offen sc1
    buffer_load_dwordx4 v[28:31], v11, s[44:47], s68 offen sc1
    buffer_load_dwordx4 v[32:35], v11, s[44:47], s69 offen sc1
    buffer_load_dwordx4 v[36:39], v11, s[44:47], s70 offen sc1
    buffer_load_dwordx4 v[40:43], v11, s[44:47], s71 offen sc1
    s_waitcnt vmcnt(0)
    v_max3_u32 v110, v12, v13, v14
    v_max3_u32 v110, v110, v15, v16
    v_max3_u32 v110, v110, v17, v18
    v_max3_u32 v110, v110, v19, v20
    v_max3_u32 v110, v110, v21, v22
    v_max3_u32 v110, v110, v23, v24
    v_max3_u32 v110, v110, v25, v26
    v_max3_u32 v110, v110, v27, v28
    v_max3_u32 v110, v110, v29, v30
    v_max3_u32 v110, v110, v31, v32
    v_max3_u32 v110, v110, v33, v34
    v_max3_u32 v110, v110, v35, v36
    v_max3_u32 v110, v110, v37, v38
    v_max3_u32 v110, v110, v39, v40
    v_max3_u32 v110, v110, v41, v42
    v_max_u32 v110, v110, v43
    v_cmp_eq_u32 vcc, -1, v110
    s_cbranch_vccz L_PQ_DONE
    s_sub_u32 s58, s58, 1
    s_cmp_eq_u32 s58, 0
    s_cbranch_scc1 L_PQ_DONE
    s_branch L_PQ_LOOP
L_PQ_DONE:
    s_nop 4
    s_mov_b64 exec, -1
    s_add_u32 s52, s51, 0
    buffer_load_dwordx4 v[164:167], v1, s[8:11], s52 offen offset:0 nt
    buffer_load_dwordx4 v[168:171], v1, s[8:11], s52 offen offset:128 nt
    buffer_load_dwordx4 v[172:175], v1, s[8:11], s52 offen offset:256 nt
    s_add_u32 s52, s51, 24576
    buffer_load_dwordx4 v[176:179], v1, s[8:11], s52 offen offset:0 nt
    buffer_load_dwordx4 v[180:183], v1, s[8:11], s52 offen offset:128 nt
    buffer_load_dwordx4 v[184:187], v1, s[8:11], s52 offen offset:256 nt
    s_add_u32 s52, s51, 49152
    buffer_load_dwordx4 v[188:191], v1, s[8:11], s52 offen offset:0 nt
    buffer_load_dwordx4 v[192:195], v1, s[8:11], s52 offen offset:128 nt
    buffer_load_dwordx4 v[196:199], v1, s[8:11], s52 offen offset:256 nt
    s_add_u32 s52, s51, 73728
    buffer_load_dwordx4 v[200:203], v1, s[8:11], s52 offen offset:0 nt
    buffer_load_dwordx4 v[204:207], v1, s[8:11], s52 offen offset:128 nt
    buffer_load_dwordx4 v[208:211], v1, s[8:11], s52 offen offset:256 nt
    s_add_u32 s52, s51, 98304
    buffer_load_dwordx4 v[212:215], v1, s[8:11], s52 offen offset:0 nt
    buffer_load_dwordx4 v[216:219], v1, s[8:11], s52 offen offset:128 nt
    buffer_load_dwordx4 v[220:223], v1, s[8:11], s52 offen offset:256 nt
    s_add_u32 s52, s51, 122880
    buffer_load_dwordx4 v[224:227], v1, s[8:11], s52 offen offset:0 nt
    buffer_load_dwordx4 v[228:231], v1, s[8:11], s52 offen offset:128 nt
    buffer_load_dwordx4 v[232:235], v1, s[8:11], s52 offen offset:256 nt
    s_add_u32 s52, s51, 147456
    buffer_load_dwordx4 v[140:143], v1, s[8:11], s52 offen offset:0 nt
    buffer_load_dwordx4 v[144:147], v1, s[8:11], s52 offen offset:128 nt
    buffer_load_dwordx4 v[148:151], v1, s[8:11], s52 offen offset:256 nt
    s_add_u32 s52, s51, 172032
    buffer_load_dwordx4 v[152:155], v1, s[8:11], s52 offen offset:0 nt
    buffer_load_dwordx4 v[156:159], v1, s[8:11], s52 offen offset:128 nt
    buffer_load_dwordx4 v[160:163], v1, s[8:11], s52 offen offset:256 nt
    s_mov_b32 exec_lo, -1
    s_mov_b32 exec_hi, 0xffff
    v_add_f32 v12, v12, v16
    v_add_f32 v13, v13, v17
    v_add_f32 v14, v14, v18
    v_add_f32 v15, v15, v19
    v_add_f32 v12, v12, v20
    v_add_f32 v13, v13, v21
    v_add_f32 v14, v14, v22
    v_add_f32 v15, v15, v23
    v_add_f32 v12, v12, v24
    v_add_f32 v13, v13, v25
    v_add_f32 v14, v14, v26
    v_add_f32 v15, v15, v27
    v_add_f32 v12, v12, v28
    v_add_f32 v13, v13, v29
    v_add_f32 v14, v14, v30
    v_add_f32 v15, v15, v31
    v_add_f32 v12, v12, v32
    v_add_f32 v13, v13, v33
    v_add_f32 v14, v14, v34
    v_add_f32 v15, v15, v35
    v_add_f32 v12, v12, v36
    v_add_f32 v13, v13, v37
    v_add_f32 v14, v14, v38
    v_add_f32 v15, v15, v39
    v_add_f32 v12, v12, v40
    v_add_f32 v13, v13, v41
    v_add_f32 v14, v14, v42
    v_add_f32 v15, v15, v43
    v_cvt_pk_bf16_f32 v12, v12, 0
    v_lshlrev_b32 v16, 1, v6
    v_cvt_pk_bf16_f32 v13, v13, 0
    v_lshlrev_b32 v17, 1, v7
    v_cvt_pk_bf16_f32 v14, v14, 0
    v_lshlrev_b32 v18, 1, v8
    v_cvt_pk_bf16_f32 v15, v15, 0
    v_lshlrev_b32 v19, 1, v9
    ds_write_b16 v16, v12 offset:6144
    ds_write_b16 v17, v13 offset:6144
    ds_write_b16 v18, v14 offset:6144
    ds_write_b16 v19, v15 offset:6144
    s_mov_b64 exec, -1
    s_waitcnt lgkmcnt(0)
    s_barrier
L_JOIN:
    s_nop 4
    v_and_b32 v12, 7, v0
    v_lshlrev_b32 v12, 4, v12
    ds_read_b128 v[44:47], v12 offset:6144
    ds_read_b128 v[48:51], v12 offset:6272
    ds_read_b128 v[52:55], v12 offset:6400
    v_mov_b32 v20, 0
    v_mov_b32 v21, 0
    v_mov_b32 v22, 0
    v_mov_b32 v23, 0
    v_mov_b32 v24, 0
    v_mov_b32 v25, 0
    v_mov_b32 v26, 0
    v_mov_b32 v27, 0
    v_mov_b32 v28, 0
    v_mov_b32 v29, 0
    v_mov_b32 v30, 0
    v_mov_b32 v31, 0
    v_mov_b32 v32, 0
    v_mov_b32 v33, 0
    v_mov_b32 v34, 0
    v_mov_b32 v35, 0
    v_mov_b32 v36, 0
    v_mov_b32 v37, 0
    v_mov_b32 v38, 0
    v_mov_b32 v39, 0
    v_mov_b32 v40, 0
    v_mov_b32 v41, 0
    v_mov_b32 v42, 0
    v_mov_b32 v43, 0
    s_waitcnt lgkmcnt(0)
    s_waitcnt vmcnt(21)
    v_dot2_f32_bf16 v12, v164, v44, 0
    v_dot2_f32_bf16 v13, v168, v48, 0
    v_dot2_f32_bf16 v14, v172, v52, 0
    v_dot2_f32_bf16 v12, v165, v45, v12
    v_dot2_f32_bf16 v13, v169, v49, v13
    v_dot2_f32_bf16 v14, v173, v53, v14
    v_dot2_f32_bf16 v12, v166, v46, v12
    v_dot2_f32_bf16 v13, v170, v50, v13
    v_dot2_f32_bf16 v14, v174, v54, v14
    v_dot2_f32_bf16 v12, v167, v47, v12
    v_dot2_f32_bf16 v13, v171, v51, v13
    v_dot2_f32_bf16 v14, v175, v55, v14
    s_add_u32 s52, s51, 196608
    buffer_load_dwordx4 v[164:167], v1, s[8:11], s52 offen offset:0 nt
    buffer_load_dwordx4 v[168:171], v1, s[8:11], s52 offen offset:128 nt
    buffer_load_dwordx4 v[172:175], v1, s[8:11], s52 offen offset:256 nt
    v_add_f32 v12, v12, v13
    v_add_f32 v12, v12, v14
    s_nop 1
    v_add_f32_dpp v13, v12, v12 quad_perm:[1,0,3,2] row_mask:0xf bank_mask:0xf
    s_nop 1
    v_add_f32_dpp v12, v13, v13 quad_perm:[2,3,0,1] row_mask:0xf bank_mask:0xf
    s_nop 1
    v_add_f32_dpp v56, v12, v12 row_half_mirror row_mask:0xf bank_mask:0xf
    s_cmp_eq_u32 s48, 2
    s_cbranch_scc0 L_G1_SKIP
    s_waitcnt vmcnt(9)
    v_mov_b32 v116, 0
    v_lshlrev_b32 v117, 16, v106
    v_and_b32 v118, 0xffff0000, v106
    v_lshlrev_b32 v119, 16, v111
    v_and_b32 v120, 0xffff0000, v111
    v_mul_f32 v117, v117, v119
    v_mul_f32 v118, v118, v120
    v_cvt_pk_bf16_f32 v117, v117, v118
    v_lshlrev_b32 v118, 16, v117
    v_and_b32 v117, 0xffff0000, v117
    v_add_f32 v116, v116, v118
    v_add_f32 v116, v116, v117
    v_lshlrev_b32 v117, 16, v107
    v_and_b32 v118, 0xffff0000, v107
    v_lshlrev_b32 v119, 16, v112
    v_and_b32 v120, 0xffff0000, v112
    v_mul_f32 v117, v117, v119
    v_mul_f32 v118, v118, v120
    v_cvt_pk_bf16_f32 v117, v117, v118
    v_lshlrev_b32 v118, 16, v117
    v_and_b32 v117, 0xffff0000, v117
    v_add_f32 v116, v116, v118
    v_add_f32 v116, v116, v117
    v_lshlrev_b32 v117, 16, v108
    v_and_b32 v118, 0xffff0000, v108
    v_lshlrev_b32 v119, 16, v113
    v_and_b32 v120, 0xffff0000, v113
    v_mul_f32 v117, v117, v119
    v_mul_f32 v118, v118, v120
    v_cvt_pk_bf16_f32 v117, v117, v118
    v_lshlrev_b32 v118, 16, v117
    v_and_b32 v117, 0xffff0000, v117
    v_add_f32 v116, v116, v118
    v_add_f32 v116, v116, v117
    v_lshlrev_b32 v117, 16, v109
    v_and_b32 v118, 0xffff0000, v109
    v_lshlrev_b32 v119, 16, v114
    v_and_b32 v120, 0xffff0000, v114
    v_mul_f32 v117, v117, v119
    v_mul_f32 v118, v118, v120
    v_cvt_pk_bf16_f32 v117, v117, v118
    v_lshlrev_b32 v118, 16, v117
    v_and_b32 v117, 0xffff0000, v117
    v_add_f32 v116, v116, v118
    v_add_f32 v116, v116, v117
    v_lshlrev_b32 v117, 16, v110
    v_and_b32 v118, 0xffff0000, v110
    v_lshlrev_b32 v119, 16, v115
    v_and_b32 v120, 0xffff0000, v115
    v_mul_f32 v117, v117, v119
    v_mul_f32 v118, v118, v120
    v_cvt_pk_bf16_f32 v117, v117, v118
    v_lshlrev_b32 v118, 16, v117
    v_and_b32 v117, 0xffff0000, v117
    v_add_f32 v116, v116, v118
    v_add_f32 v116, v116, v117
    s_nop 1
    v_add_f32_dpp v117, v116, v116 quad_perm:[1,0,3,2] row_mask:0xf bank_mask:0xf
    s_nop 1
    v_add_f32_dpp v116, v117, v117 quad_perm:[2,3,0,1] row_mask:0xf bank_mask:0xf
    s_nop 1
    v_add_f32_dpp v117, v116, v116 row_half_mirror row_mask:0xf bank_mask:0xf
    s_nop 1
    v_add_f32_dpp v12, v117, v117 row_ror:8 row_mask:0xf bank_mask:0xf
    s_nop 0
    v_readlane_b32 s64, v12, 0
    v_readlane_b32 s65, v12, 16
    v_readlane_b32 s66, v12, 32
    v_readlane_b32 s67, v12, 48
    v_mov_b32 v116, s64
    v_add_f32 v116, s65, v116
    v_add_f32 v116, s66, v116
    v_add_f32 v116, s67, v116
    v_cvt_pk_bf16_f32 v116, v116, 0
    v_lshlrev_b32 v116, 16, v116
    v_mul_f32 v117, 0xbfb8aa3b, v116
    v_exp_f32 v117, v117
    s_nop 0
    v_add_f32 v117, 1.0, v117
    v_rcp_f32 v117, v117
    s_nop 0
    v_cvt_pk_bf16_f32 v117, v117, 0
    v_lshlrev_b32 v117, 16, v117
    v_mov_b32 v118, 13888
    ds_write_b32 v118, v117
L_G1_SKIP:
    s_nop 4
    s_waitcnt vmcnt(21)
    v_dot2_f32_bf16 v12, v176, v44, 0
    v_dot2_f32_bf16 v13, v180, v48, 0
    v_dot2_f32_bf16 v14, v184, v52, 0
    v_dot2_f32_bf16 v12, v177, v45, v12
    v_dot2_f32_bf16 v13, v181, v49, v13
    v_dot2_f32_bf16 v14, v185, v53, v14
    v_dot2_f32_bf16 v12, v178, v46, v12
    v_dot2_f32_bf16 v13, v182, v50, v13
    v_dot2_f32_bf16 v14, v186, v54, v14
    v_dot2_f32_bf16 v12, v179, v47, v12
    v_dot2_f32_bf16 v13, v183, v51, v13
    v_dot2_f32_bf16 v14, v187, v55, v14
    s_add_u32 s52, s51, 221184
    buffer_load_dwordx4 v[176:179], v1, s[8:11], s52 offen offset:0 nt
    buffer_load_dwordx4 v[180:183], v1, s[8:11], s52 offen offset:128 nt
    buffer_load_dwordx4 v[184:187], v1, s[8:11], s52 offen offset:256 nt
    v_add_f32 v12, v12, v13
    v_add_f32 v12, v12, v14
    s_nop 1
    v_add_f32_dpp v13, v12, v12 quad_perm:[1,0,3,2] row_mask:0xf bank_mask:0xf
    s_nop 1
    v_add_f32_dpp v12, v13, v13 quad_perm:[2,3,0,1] row_mask:0xf bank_mask:0xf
    s_nop 1
    v_add_f32_dpp v57, v12, v12 row_half_mirror row_mask:0xf bank_mask:0xf
    s_mul_i32 s55, s49, 245760
    s_mul_i32 s56, s50, 160
    s_add_u32 s55, s55, s56
    s_add_u32 s55, s55, 0
    buffer_load_dword v72, v4, s[20:23], s55 offen offset:0 nt
    s_mul_i32 s55, s49, 245760
    s_mul_i32 s56, s50, 160
    s_add_u32 s55, s55, s56
    s_add_u32 s55, s55, 0
    buffer_load_dword v73, v4, s[20:23], s55 offen offset:1280 nt
    s_cmp_eq_u32 s48, 1
    s_cbranch_scc0 L_C0_SKIP
    v_lshlrev_b32 v139, 2, v0
    buffer_load_dword v138, v139, s[40:43], 0 offen sc1
L_C0_SKIP:
    s_nop 4
    s_waitcnt vmcnt(23)
    v_dot2_f32_bf16 v12, v188, v44, 0
    v_dot2_f32_bf16 v13, v192, v48, 0
    v_dot2_f32_bf16 v14, v196, v52, 0
    v_dot2_f32_bf16 v12, v189, v45, v12
    v_dot2_f32_bf16 v13, v193, v49, v13
    v_dot2_f32_bf16 v14, v197, v53, v14
    v_dot2_f32_bf16 v12, v190, v46, v12
    v_dot2_f32_bf16 v13, v194, v50, v13
    v_dot2_f32_bf16 v14, v198, v54, v14
    v_dot2_f32_bf16 v12, v191, v47, v12
    v_dot2_f32_bf16 v13, v195, v51, v13
    v_dot2_f32_bf16 v14, v199, v55, v14
    s_add_u32 s52, s51, 245760
    buffer_load_dwordx4 v[188:191], v1, s[8:11], s52 offen offset:0 nt
    buffer_load_dwordx4 v[192:195], v1, s[8:11], s52 offen offset:128 nt
    buffer_load_dwordx4 v[196:199], v1, s[8:11], s52 offen offset:256 nt
    v_add_f32 v12, v12, v13
    v_add_f32 v12, v12, v14
    s_nop 1
    v_add_f32_dpp v13, v12, v12 quad_perm:[1,0,3,2] row_mask:0xf bank_mask:0xf
    s_nop 1
    v_add_f32_dpp v12, v13, v13 quad_perm:[2,3,0,1] row_mask:0xf bank_mask:0xf
    s_nop 1
    v_add_f32_dpp v58, v12, v12 row_half_mirror row_mask:0xf bank_mask:0xf
    s_mul_i32 s55, s49, 245760
    s_mul_i32 s56, s50, 160
    s_add_u32 s55, s55, s56
    s_add_u32 s55, s55, 0
    buffer_load_dword v74, v4, s[20:23], s55 offen offset:2560 nt
    s_mul_i32 s55, s49, 245760
    s_mul_i32 s56, s50, 160
    s_add_u32 s55, s55, s56
    s_add_u32 s55, s55, 0
    buffer_load_dword v75, v4, s[20:23], s55 offen offset:3840 nt
    s_waitcnt vmcnt(25)
    v_dot2_f32_bf16 v12, v200, v44, 0
    v_dot2_f32_bf16 v13, v204, v48, 0
    v_dot2_f32_bf16 v14, v208, v52, 0
    v_dot2_f32_bf16 v12, v201, v45, v12
    v_dot2_f32_bf16 v13, v205, v49, v13
    v_dot2_f32_bf16 v14, v209, v53, v14
    v_dot2_f32_bf16 v12, v202, v46, v12
    v_dot2_f32_bf16 v13, v206, v50, v13
    v_dot2_f32_bf16 v14, v210, v54, v14
    v_dot2_f32_bf16 v12, v203, v47, v12
    v_dot2_f32_bf16 v13, v207, v51, v13
    v_dot2_f32_bf16 v14, v211, v55, v14
    s_add_u32 s52, s51, 270336
    buffer_load_dwordx4 v[200:203], v1, s[8:11], s52 offen offset:0 nt
    buffer_load_dwordx4 v[204:207], v1, s[8:11], s52 offen offset:128 nt
    buffer_load_dwordx4 v[208:211], v1, s[8:11], s52 offen offset:256 nt
    v_add_f32 v12, v12, v13
    v_add_f32 v12, v12, v14
    s_nop 1
    v_add_f32_dpp v13, v12, v12 quad_perm:[1,0,3,2] row_mask:0xf bank_mask:0xf
    s_nop 1
    v_add_f32_dpp v12, v13, v13 quad_perm:[2,3,0,1] row_mask:0xf bank_mask:0xf
    s_nop 1
    v_add_f32_dpp v59, v12, v12 row_half_mirror row_mask:0xf bank_mask:0xf
    s_mul_i32 s55, s49, 245760
    s_mul_i32 s56, s50, 160
    s_add_u32 s55, s55, s56
    s_add_u32 s55, s55, 5120
    buffer_load_dword v76, v4, s[20:23], s55 offen offset:0 nt
    s_mul_i32 s55, s49, 245760
    s_mul_i32 s56, s50, 160
    s_add_u32 s55, s55, s56
    s_add_u32 s55, s55, 5120
    buffer_load_dword v77, v4, s[20:23], s55 offen offset:1280 nt
    s_waitcnt vmcnt(27)
    v_dot2_f32_bf16 v12, v212, v44, 0
    v_dot2_f32_bf16 v13, v216, v48, 0
    v_dot2_f32_bf16 v14, v220, v52, 0
    v_dot2_f32_bf16 v12, v213, v45, v12
    v_dot2_f32_bf16 v13, v217, v49, v13
    v_dot2_f32_bf16 v14, v221, v53, v14
    v_dot2_f32_bf16 v12, v214, v46, v12
    v_dot2_f32_bf16 v13, v218, v50, v13
    v_dot2_f32_bf16 v14, v222, v54, v14
    v_dot2_f32_bf16 v12, v215, v47, v12
    v_dot2_f32_bf16 v13, v219, v51, v13
    v_dot2_f32_bf16 v14, v223, v55, v14
    s_add_u32 s52, s51, 294912
    buffer_load_dwordx4 v[212:215], v1, s[8:11], s52 offen offset:0 nt
    buffer_load_dwordx4 v[216:219], v1, s[8:11], s52 offen offset:128 nt
    buffer_load_dwordx4 v[220:223], v1, s[8:11], s52 offen offset:256 nt
    v_add_f32 v12, v12, v13
    v_add_f32 v12, v12, v14
    s_nop 1
    v_add_f32_dpp v13, v12, v12 quad_perm:[1,0,3,2] row_mask:0xf bank_mask:0xf
    s_nop 1
    v_add_f32_dpp v12, v13, v13 quad_perm:[2,3,0,1] row_mask:0xf bank_mask:0xf
    s_nop 1
    v_add_f32_dpp v60, v12, v12 row_half_mirror row_mask:0xf bank_mask:0xf
    s_mul_i32 s55, s49, 245760
    s_mul_i32 s56, s50, 160
    s_add_u32 s55, s55, s56
    s_add_u32 s55, s55, 5120
    buffer_load_dword v78, v4, s[20:23], s55 offen offset:2560 nt
    s_mul_i32 s55, s49, 245760
    s_mul_i32 s56, s50, 160
    s_add_u32 s55, s55, s56
    s_add_u32 s55, s55, 5120
    buffer_load_dword v79, v4, s[20:23], s55 offen offset:3840 nt
    s_waitcnt vmcnt(29)
    v_dot2_f32_bf16 v12, v224, v44, 0
    v_dot2_f32_bf16 v13, v228, v48, 0
    v_dot2_f32_bf16 v14, v232, v52, 0
    v_dot2_f32_bf16 v12, v225, v45, v12
    v_dot2_f32_bf16 v13, v229, v49, v13
    v_dot2_f32_bf16 v14, v233, v53, v14
    v_dot2_f32_bf16 v12, v226, v46, v12
    v_dot2_f32_bf16 v13, v230, v50, v13
    v_dot2_f32_bf16 v14, v234, v54, v14
    v_dot2_f32_bf16 v12, v227, v47, v12
    v_dot2_f32_bf16 v13, v231, v51, v13
    v_dot2_f32_bf16 v14, v235, v55, v14
    s_add_u32 s52, s51, 319488
    buffer_load_dwordx4 v[224:227], v1, s[8:11], s52 offen offset:0 nt
    buffer_load_dwordx4 v[228:231], v1, s[8:11], s52 offen offset:128 nt
    buffer_load_dwordx4 v[232:235], v1, s[8:11], s52 offen offset:256 nt
    v_add_f32 v12, v12, v13
    v_add_f32 v12, v12, v14
    s_nop 1
    v_add_f32_dpp v13, v12, v12 quad_perm:[1,0,3,2] row_mask:0xf bank_mask:0xf
    s_nop 1
    v_add_f32_dpp v12, v13, v13 quad_perm:[2,3,0,1] row_mask:0xf bank_mask:0xf
    s_nop 1
    v_add_f32_dpp v61, v12, v12 row_half_mirror row_mask:0xf bank_mask:0xf
    s_mul_i32 s55, s49, 245760
    s_mul_i32 s56, s50, 160
    s_add_u32 s55, s55, s56
    s_add_u32 s55, s55, 10240
    buffer_load_dword v80, v4, s[20:23], s55 offen offset:0 nt
    s_mul_i32 s55, s49, 245760
    s_mul_i32 s56, s50, 160
    s_add_u32 s55, s55, s56
    s_add_u32 s55, s55, 10240
    buffer_load_dword v81, v4, s[20:23], s55 offen offset:1280 nt
    s_waitcnt vmcnt(31)
    v_dot2_f32_bf16 v12, v140, v44, 0
    v_dot2_f32_bf16 v13, v144, v48, 0
    v_dot2_f32_bf16 v14, v148, v52, 0
    v_dot2_f32_bf16 v12, v141, v45, v12
    v_dot2_f32_bf16 v13, v145, v49, v13
    v_dot2_f32_bf16 v14, v149, v53, v14
    v_dot2_f32_bf16 v12, v142, v46, v12
    v_dot2_f32_bf16 v13, v146, v50, v13
    v_dot2_f32_bf16 v14, v150, v54, v14
    v_dot2_f32_bf16 v12, v143, v47, v12
    v_dot2_f32_bf16 v13, v147, v51, v13
    v_dot2_f32_bf16 v14, v151, v55, v14
    s_add_u32 s52, s51, 344064
    buffer_load_dwordx4 v[140:143], v1, s[8:11], s52 offen offset:0 nt
    buffer_load_dwordx4 v[144:147], v1, s[8:11], s52 offen offset:128 nt
    buffer_load_dwordx4 v[148:151], v1, s[8:11], s52 offen offset:256 nt
    v_add_f32 v12, v12, v13
    v_add_f32 v12, v12, v14
    s_nop 1
    v_add_f32_dpp v13, v12, v12 quad_perm:[1,0,3,2] row_mask:0xf bank_mask:0xf
    s_nop 1
    v_add_f32_dpp v12, v13, v13 quad_perm:[2,3,0,1] row_mask:0xf bank_mask:0xf
    s_nop 1
    v_add_f32_dpp v62, v12, v12 row_half_mirror row_mask:0xf bank_mask:0xf
    s_mul_i32 s55, s49, 245760
    s_mul_i32 s56, s50, 160
    s_add_u32 s55, s55, s56
    s_add_u32 s55, s55, 10240
    buffer_load_dword v82, v4, s[20:23], s55 offen offset:2560 nt
    s_mul_i32 s55, s49, 245760
    s_mul_i32 s56, s50, 160
    s_add_u32 s55, s55, s56
    s_add_u32 s55, s55, 10240
    buffer_load_dword v83, v4, s[20:23], s55 offen offset:3840 nt
    s_waitcnt vmcnt(33)
    v_dot2_f32_bf16 v12, v152, v44, 0
    v_dot2_f32_bf16 v13, v156, v48, 0
    v_dot2_f32_bf16 v14, v160, v52, 0
    v_dot2_f32_bf16 v12, v153, v45, v12
    v_dot2_f32_bf16 v13, v157, v49, v13
    v_dot2_f32_bf16 v14, v161, v53, v14
    v_dot2_f32_bf16 v12, v154, v46, v12
    v_dot2_f32_bf16 v13, v158, v50, v13
    v_dot2_f32_bf16 v14, v162, v54, v14
    v_dot2_f32_bf16 v12, v155, v47, v12
    v_dot2_f32_bf16 v13, v159, v51, v13
    v_dot2_f32_bf16 v14, v163, v55, v14
    s_add_u32 s52, s51, 368640
    buffer_load_dwordx4 v[152:155], v1, s[8:11], s52 offen offset:0 nt
    buffer_load_dwordx4 v[156:159], v1, s[8:11], s52 offen offset:128 nt
    buffer_load_dwordx4 v[160:163], v1, s[8:11], s52 offen offset:256 nt
    v_add_f32 v12, v12, v13
    v_add_f32 v12, v12, v14
    s_nop 1
    v_add_f32_dpp v13, v12, v12 quad_perm:[1,0,3,2] row_mask:0xf bank_mask:0xf
    s_nop 1
    v_add_f32_dpp v12, v13, v13 quad_perm:[2,3,0,1] row_mask:0xf bank_mask:0xf
    s_nop 1
    v_add_f32_dpp v63, v12, v12 row_half_mirror row_mask:0xf bank_mask:0xf
    s_mul_i32 s55, s49, 245760
    s_mul_i32 s56, s50, 160
    s_add_u32 s55, s55, s56
    s_add_u32 s55, s55, 15360
    buffer_load_dword v84, v4, s[20:23], s55 offen offset:0 nt
    s_mul_i32 s55, s49, 245760
    s_mul_i32 s56, s50, 160
    s_add_u32 s55, s55, s56
    s_add_u32 s55, s55, 15360
    buffer_load_dword v85, v4, s[20:23], s55 offen offset:1280 nt
    s_waitcnt vmcnt(35)
    v_dot2_f32_bf16 v12, v164, v44, 0
    v_dot2_f32_bf16 v13, v168, v48, 0
    v_dot2_f32_bf16 v14, v172, v52, 0
    v_dot2_f32_bf16 v12, v165, v45, v12
    v_dot2_f32_bf16 v13, v169, v49, v13
    v_dot2_f32_bf16 v14, v173, v53, v14
    v_dot2_f32_bf16 v12, v166, v46, v12
    v_dot2_f32_bf16 v13, v170, v50, v13
    v_dot2_f32_bf16 v14, v174, v54, v14
    v_dot2_f32_bf16 v12, v167, v47, v12
    v_dot2_f32_bf16 v13, v171, v51, v13
    v_dot2_f32_bf16 v14, v175, v55, v14
    s_add_u32 s52, s51, 0
    buffer_load_dwordx4 v[164:167], v1, s[12:15], s52 offen offset:0 nt
    buffer_load_dwordx4 v[168:171], v1, s[12:15], s52 offen offset:128 nt
    buffer_load_dwordx4 v[172:175], v1, s[12:15], s52 offen offset:256 nt
    v_add_f32 v12, v12, v13
    v_add_f32 v12, v12, v14
    s_nop 1
    v_add_f32_dpp v13, v12, v12 quad_perm:[1,0,3,2] row_mask:0xf bank_mask:0xf
    s_nop 1
    v_add_f32_dpp v12, v13, v13 quad_perm:[2,3,0,1] row_mask:0xf bank_mask:0xf
    s_nop 1
    v_add_f32_dpp v64, v12, v12 row_half_mirror row_mask:0xf bank_mask:0xf
    s_mul_i32 s55, s49, 245760
    s_mul_i32 s56, s50, 160
    s_add_u32 s55, s55, s56
    s_add_u32 s55, s55, 15360
    buffer_load_dword v86, v4, s[20:23], s55 offen offset:2560 nt
    s_mul_i32 s55, s49, 245760
    s_mul_i32 s56, s50, 160
    s_add_u32 s55, s55, s56
    s_add_u32 s55, s55, 15360
    buffer_load_dword v87, v4, s[20:23], s55 offen offset:3840 nt
    s_waitcnt vmcnt(37)
    v_dot2_f32_bf16 v12, v176, v44, 0
    v_dot2_f32_bf16 v13, v180, v48, 0
    v_dot2_f32_bf16 v14, v184, v52, 0
    v_dot2_f32_bf16 v12, v177, v45, v12
    v_dot2_f32_bf16 v13, v181, v49, v13
    v_dot2_f32_bf16 v14, v185, v53, v14
    v_dot2_f32_bf16 v12, v178, v46, v12
    v_dot2_f32_bf16 v13, v182, v50, v13
    v_dot2_f32_bf16 v14, v186, v54, v14
    v_dot2_f32_bf16 v12, v179, v47, v12
    v_dot2_f32_bf16 v13, v183, v51, v13
    v_dot2_f32_bf16 v14, v187, v55, v14
    s_add_u32 s52, s51, 24576
    buffer_load_dwordx4 v[176:179], v1, s[12:15], s52 offen offset:0 nt
    buffer_load_dwordx4 v[180:183], v1, s[12:15], s52 offen offset:128 nt
    buffer_load_dwordx4 v[184:187], v1, s[12:15], s52 offen offset:256 nt
    v_add_f32 v12, v12, v13
    v_add_f32 v12, v12, v14
    s_nop 1
    v_add_f32_dpp v13, v12, v12 quad_perm:[1,0,3,2] row_mask:0xf bank_mask:0xf
    s_nop 1
    v_add_f32_dpp v12, v13, v13 quad_perm:[2,3,0,1] row_mask:0xf bank_mask:0xf
    s_nop 1
    v_add_f32_dpp v65, v12, v12 row_half_mirror row_mask:0xf bank_mask:0xf
    s_mul_i32 s55, s49, 245760
    s_mul_i32 s56, s50, 160
    s_add_u32 s55, s55, s56
    s_add_u32 s55, s55, 20480
    buffer_load_dword v88, v4, s[20:23], s55 offen offset:0 nt
    s_mul_i32 s55, s49, 245760
    s_mul_i32 s56, s50, 160
    s_add_u32 s55, s55, s56
    s_add_u32 s55, s55, 20480
    buffer_load_dword v89, v4, s[20:23], s55 offen offset:1280 nt
    s_waitcnt vmcnt(37)
    v_dot2_f32_bf16 v12, v188, v44, 0
    v_dot2_f32_bf16 v13, v192, v48, 0
    v_dot2_f32_bf16 v14, v196, v52, 0
    v_dot2_f32_bf16 v12, v189, v45, v12
    v_dot2_f32_bf16 v13, v193, v49, v13
    v_dot2_f32_bf16 v14, v197, v53, v14
    v_dot2_f32_bf16 v12, v190, v46, v12
    v_dot2_f32_bf16 v13, v194, v50, v13
    v_dot2_f32_bf16 v14, v198, v54, v14
    v_dot2_f32_bf16 v12, v191, v47, v12
    v_dot2_f32_bf16 v13, v195, v51, v13
    v_dot2_f32_bf16 v14, v199, v55, v14
    s_add_u32 s52, s51, 49152
    buffer_load_dwordx4 v[188:191], v1, s[12:15], s52 offen offset:0 nt
    buffer_load_dwordx4 v[192:195], v1, s[12:15], s52 offen offset:128 nt
    buffer_load_dwordx4 v[196:199], v1, s[12:15], s52 offen offset:256 nt
    v_add_f32 v12, v12, v13
    v_add_f32 v12, v12, v14
    s_nop 1
    v_add_f32_dpp v13, v12, v12 quad_perm:[1,0,3,2] row_mask:0xf bank_mask:0xf
    s_nop 1
    v_add_f32_dpp v12, v13, v13 quad_perm:[2,3,0,1] row_mask:0xf bank_mask:0xf
    s_nop 1
    v_add_f32_dpp v66, v12, v12 row_half_mirror row_mask:0xf bank_mask:0xf
    s_mul_i32 s55, s49, 245760
    s_mul_i32 s56, s50, 160
    s_add_u32 s55, s55, s56
    s_add_u32 s55, s55, 20480
    buffer_load_dword v90, v4, s[20:23], s55 offen offset:2560 nt
    s_mul_i32 s55, s49, 245760
    s_mul_i32 s56, s50, 160
    s_add_u32 s55, s55, s56
    s_add_u32 s55, s55, 20480
    buffer_load_dword v91, v4, s[20:23], s55 offen offset:3840 nt
    s_cmp_eq_u32 s48, 1
    s_cbranch_scc0 L_C1_SKIP
    s_waitcnt vmcnt(45)
    s_mov_b32 s58, 400000
L_C1_LOOP:
    s_nop 4
    v_subrev_u32 v136, 0x01010101, v138
    v_not_b32 v137, v138
    v_and_b32 v136, v136, v137
    v_and_b32 v136, 0x80808080, v136
    v_cmp_ne_u32 vcc, 0, v136
    s_cbranch_vccz L_C1_OK
    s_sub_u32 s58, s58, 1
    s_cmp_eq_u32 s58, 0
    s_cbranch_scc1 L_C1_OK
    s_sleep 2
    buffer_load_dword v138, v139, s[40:43], 0 offen sc1
    s_waitcnt vmcnt(0)
    s_branch L_C1_LOOP
L_C1_OK:
    s_nop 4
    s_mov_b32 exec_lo, -1
    s_mov_b32 exec_hi, 0xffff
    s_lshr_b32 s55, s49, 2
    s_mul_i32 s55, s55, 12288
    s_and_b32 s56, s49, 3
    s_mul_i32 s56, s56, 192
    s_add_u32 s55, s55, s56
    s_add_u32 s55, s55, 0
    s_add_u32 s56, s55, 0
    buffer_load_dword v106, v139, s[44:47], s56 offen offset:0 sc1
    buffer_load_dword v107, v139, s[44:47], s56 offen offset:768 sc1
    buffer_load_dword v108, v139, s[44:47], s56 offen offset:1536 sc1
    buffer_load_dword v109, v139, s[44:47], s56 offen offset:2304 sc1
    s_add_u32 s56, s55, 3072
    buffer_load_dword v110, v139, s[44:47], s56 offen offset:0 sc1
    buffer_load_dword v111, v139, s[44:47], s56 offen offset:768 sc1
    buffer_load_dword v112, v139, s[44:47], s56 offen offset:1536 sc1
    buffer_load_dword v113, v139, s[44:47], s56 offen offset:2304 sc1
    s_add_u32 s56, s55, 6144
    buffer_load_dword v114, v139, s[44:47], s56 offen offset:0 sc1
    buffer_load_dword v115, v139, s[44:47], s56 offen offset:768 sc1
    buffer_load_dword v116, v139, s[44:47], s56 offen offset:1536 sc1
    buffer_load_dword v117, v139, s[44:47], s56 offen offset:2304 sc1
    s_add_u32 s56, s55, 9216
    buffer_load_dword v118, v139, s[44:47], s56 offen offset:0 sc1
    buffer_load_dword v119, v139, s[44:47], s56 offen offset:768 sc1
    buffer_load_dword v120, v139, s[44:47], s56 offen offset:1536 sc1
    buffer_load_dword v121, v139, s[44:47], s56 offen offset:2304 sc1
    s_add_u32 s56, s55, 98304
    buffer_load_dword v122, v139, s[44:47], s56 offen offset:0 sc1
    buffer_load_dword v123, v139, s[44:47], s56 offen offset:768 sc1
    buffer_load_dword v124, v139, s[44:47], s56 offen offset:1536 sc1
    buffer_load_dword v125, v139, s[44:47], s56 offen offset:2304 sc1
    s_add_u32 s56, s55, 101376
    buffer_load_dword v126, v139, s[44:47], s56 offen offset:0 sc1
    buffer_load_dword v127, v139, s[44:47], s56 offen offset:768 sc1
    buffer_load_dword v128, v139, s[44:47], s56 offen offset:1536 sc1
    buffer_load_dword v129, v139, s[44:47], s56 offen offset:2304 sc1
    s_add_u32 s56, s55, 104448
    buffer_load_dword v130, v139, s[44:47], s56 offen offset:0 sc1
    buffer_load_dword v131, v139, s[44:47], s56 offen offset:768 sc1
    buffer_load_dword v132, v139, s[44:47], s56 offen offset:1536 sc1
    buffer_load_dword v133, v139, s[44:47], s56 offen offset:2304 sc1
    s_add_u32 s56, s55, 107520
    buffer_load_dword v134, v139, s[44:47], s56 offen offset:0 sc1
    buffer_load_dword v135, v139, s[44:47], s56 offen offset:768 sc1
    buffer_load_dword v136, v139, s[44:47], s56 offen offset:1536 sc1
    buffer_load_dword v137, v139, s[44:47], s56 offen offset:2304 sc1
    s_mov_b64 exec, -1
L_C1_SKIP:
    s_nop 4
    s_waitcnt vmcnt(37)
    v_dot2_f32_bf16 v12, v200, v44, 0
    v_dot2_f32_bf16 v13, v204, v48, 0
    v_dot2_f32_bf16 v14, v208, v52, 0
    v_dot2_f32_bf16 v12, v201, v45, v12
    v_dot2_f32_bf16 v13, v205, v49, v13
    v_dot2_f32_bf16 v14, v209, v53, v14
    v_dot2_f32_bf16 v12, v202, v46, v12
    v_dot2_f32_bf16 v13, v206, v50, v13
    v_dot2_f32_bf16 v14, v210, v54, v14
    v_dot2_f32_bf16 v12, v203, v47, v12
    v_dot2_f32_bf16 v13, v207, v51, v13
    v_dot2_f32_bf16 v14, v211, v55, v14
    s_add_u32 s52, s51, 73728
    buffer_load_dwordx4 v[200:203], v1, s[12:15], s52 offen offset:0 nt
    buffer_load_dwordx4 v[204:207], v1, s[12:15], s52 offen offset:128 nt
    buffer_load_dwordx4 v[208:211], v1, s[12:15], s52 offen offset:256 nt
    v_add_f32 v12, v12, v13
    v_add_f32 v12, v12, v14
    s_nop 1
    v_add_f32_dpp v13, v12, v12 quad_perm:[1,0,3,2] row_mask:0xf bank_mask:0xf
    s_nop 1
    v_add_f32_dpp v12, v13, v13 quad_perm:[2,3,0,1] row_mask:0xf bank_mask:0xf
    s_nop 1
    v_add_f32_dpp v67, v12, v12 row_half_mirror row_mask:0xf bank_mask:0xf
    s_mul_i32 s55, s49, 245760
    s_mul_i32 s56, s50, 160
    s_add_u32 s55, s55, s56
    s_add_u32 s55, s55, 25600
    buffer_load_dword v92, v4, s[20:23], s55 offen offset:0 nt
    s_mul_i32 s55, s49, 245760
    s_mul_i32 s56, s50, 160
    s_add_u32 s55, s55, s56
    s_add_u32 s55, s55, 25600
    buffer_load_dword v93, v4, s[20:23], s55 offen offset:1280 nt
    s_waitcnt vmcnt(37)
    v_dot2_f32_bf16 v12, v212, v44, 0
    v_dot2_f32_bf16 v13, v216, v48, 0
    v_dot2_f32_bf16 v14, v220, v52, 0
    v_dot2_f32_bf16 v12, v213, v45, v12
    v_dot2_f32_bf16 v13, v217, v49, v13
    v_dot2_f32_bf16 v14, v221, v53, v14
    v_dot2_f32_bf16 v12, v214, v46, v12
    v_dot2_f32_bf16 v13, v218, v50, v13
    v_dot2_f32_bf16 v14, v222, v54, v14
    v_dot2_f32_bf16 v12, v215, v47, v12
    v_dot2_f32_bf16 v13, v219, v51, v13
    v_dot2_f32_bf16 v14, v223, v55, v14
    s_add_u32 s52, s51, 98304
    buffer_load_dwordx4 v[212:215], v1, s[12:15], s52 offen offset:0 nt
    buffer_load_dwordx4 v[216:219], v1, s[12:15], s52 offen offset:128 nt
    buffer_load_dwordx4 v[220:223], v1, s[12:15], s52 offen offset:256 nt
    v_add_f32 v12, v12, v13
    v_add_f32 v12, v12, v14
    s_nop 1
    v_add_f32_dpp v13, v12, v12 quad_perm:[1,0,3,2] row_mask:0xf bank_mask:0xf
    s_nop 1
    v_add_f32_dpp v12, v13, v13 quad_perm:[2,3,0,1] row_mask:0xf bank_mask:0xf
    s_nop 1
    v_add_f32_dpp v68, v12, v12 row_half_mirror row_mask:0xf bank_mask:0xf
    s_mul_i32 s55, s49, 245760
    s_mul_i32 s56, s50, 160
    s_add_u32 s55, s55, s56
    s_add_u32 s55, s55, 25600
    buffer_load_dword v94, v4, s[20:23], s55 offen offset:2560 nt
    s_mul_i32 s55, s49, 245760
    s_mul_i32 s56, s50, 160
    s_add_u32 s55, s55, s56
    s_add_u32 s55, s55, 25600
    buffer_load_dword v95, v4, s[20:23], s55 offen offset:3840 nt
    s_waitcnt vmcnt(37)
    v_dot2_f32_bf16 v12, v224, v44, 0
    v_dot2_f32_bf16 v13, v228, v48, 0
    v_dot2_f32_bf16 v14, v232, v52, 0
    v_dot2_f32_bf16 v12, v225, v45, v12
    v_dot2_f32_bf16 v13, v229, v49, v13
    v_dot2_f32_bf16 v14, v233, v53, v14
    v_dot2_f32_bf16 v12, v226, v46, v12
    v_dot2_f32_bf16 v13, v230, v50, v13
    v_dot2_f32_bf16 v14, v234, v54, v14
    v_dot2_f32_bf16 v12, v227, v47, v12
    v_dot2_f32_bf16 v13, v231, v51, v13
    v_dot2_f32_bf16 v14, v235, v55, v14
    s_add_u32 s52, s51, 122880
    buffer_load_dwordx4 v[224:227], v1, s[12:15], s52 offen offset:0 nt
    buffer_load_dwordx4 v[228:231], v1, s[12:15], s52 offen offset:128 nt
    buffer_load_dwordx4 v[232:235], v1, s[12:15], s52 offen offset:256 nt
    v_add_f32 v12, v12, v13
    v_add_f32 v12, v12, v14
    s_nop 1
    v_add_f32_dpp v13, v12, v12 quad_perm:[1,0,3,2] row_mask:0xf bank_mask:0xf
    s_nop 1
    v_add_f32_dpp v12, v13, v13 quad_perm:[2,3,0,1] row_mask:0xf bank_mask:0xf
    s_nop 1
    v_add_f32_dpp v69, v12, v12 row_half_mirror row_mask:0xf bank_mask:0xf
    s_mul_i32 s55, s49, 61440
    s_mul_i32 s56, s50, 160
    s_add_u32 s55, s55, s56
    s_add_u32 s55, s55, 0
    buffer_load_dword v96, v5, s[28:31], s55 offen offset:0 nt
    s_mul_i32 s55, s49, 61440
    s_mul_i32 s56, s50, 160
    s_add_u32 s55, s55, s56
    s_add_u32 s55, s55, 0
    buffer_load_dword v97, v5, s[28:31], s55 offen offset:1280 nt
    s_waitcnt vmcnt(37)
    v_dot2_f32_bf16 v12, v140, v44, 0
    v_dot2_f32_bf16 v13, v144, v48, 0
    v_dot2_f32_bf16 v14, v148, v52, 0
    v_dot2_f32_bf16 v12, v141, v45, v12
    v_dot2_f32_bf16 v13, v145, v49, v13
    v_dot2_f32_bf16 v14, v149, v53, v14
    v_dot2_f32_bf16 v12, v142, v46, v12
    v_dot2_f32_bf16 v13, v146, v50, v13
    v_dot2_f32_bf16 v14, v150, v54, v14
    v_dot2_f32_bf16 v12, v143, v47, v12
    v_dot2_f32_bf16 v13, v147, v51, v13
    v_dot2_f32_bf16 v14, v151, v55, v14
    s_add_u32 s52, s51, 147456
    buffer_load_dwordx4 v[140:143], v1, s[12:15], s52 offen offset:0 nt
    buffer_load_dwordx4 v[144:147], v1, s[12:15], s52 offen offset:128 nt
    buffer_load_dwordx4 v[148:151], v1, s[12:15], s52 offen offset:256 nt
    v_add_f32 v12, v12, v13
    v_add_f32 v12, v12, v14
    s_nop 1
    v_add_f32_dpp v13, v12, v12 quad_perm:[1,0,3,2] row_mask:0xf bank_mask:0xf
    s_nop 1
    v_add_f32_dpp v12, v13, v13 quad_perm:[2,3,0,1] row_mask:0xf bank_mask:0xf
    s_nop 1
    v_add_f32_dpp v70, v12, v12 row_half_mirror row_mask:0xf bank_mask:0xf
    s_mul_i32 s55, s49, 61440
    s_mul_i32 s56, s50, 160
    s_add_u32 s55, s55, s56
    s_add_u32 s55, s55, 0
    buffer_load_dword v98, v5, s[28:31], s55 offen offset:2560 nt
    s_mul_i32 s55, s49, 61440
    s_mul_i32 s56, s50, 160
    s_add_u32 s55, s55, s56
    s_add_u32 s55, s55, 0
    buffer_load_dword v99, v5, s[28:31], s55 offen offset:3840 nt
    s_waitcnt vmcnt(37)
    v_dot2_f32_bf16 v12, v152, v44, 0
    v_dot2_f32_bf16 v13, v156, v48, 0
    v_dot2_f32_bf16 v14, v160, v52, 0
    v_dot2_f32_bf16 v12, v153, v45, v12
    v_dot2_f32_bf16 v13, v157, v49, v13
    v_dot2_f32_bf16 v14, v161, v53, v14
    v_dot2_f32_bf16 v12, v154, v46, v12
    v_dot2_f32_bf16 v13, v158, v50, v13
    v_dot2_f32_bf16 v14, v162, v54, v14
    v_dot2_f32_bf16 v12, v155, v47, v12
    v_dot2_f32_bf16 v13, v159, v51, v13
    v_dot2_f32_bf16 v14, v163, v55, v14
    s_add_u32 s52, s51, 172032
    buffer_load_dwordx4 v[152:155], v1, s[12:15], s52 offen offset:0 nt
    buffer_load_dwordx4 v[156:159], v1, s[12:15], s52 offen offset:128 nt
    buffer_load_dwordx4 v[160:163], v1, s[12:15], s52 offen offset:256 nt
    v_add_f32 v12, v12, v13
    v_add_f32 v12, v12, v14
    s_nop 1
    v_add_f32_dpp v13, v12, v12 quad_perm:[1,0,3,2] row_mask:0xf bank_mask:0xf
    s_nop 1
    v_add_f32_dpp v12, v13, v13 quad_perm:[2,3,0,1] row_mask:0xf bank_mask:0xf
    s_nop 1
    v_add_f32_dpp v71, v12, v12 row_half_mirror row_mask:0xf bank_mask:0xf
    s_mul_i32 s55, s49, 61440
    s_mul_i32 s56, s50, 160
    s_add_u32 s55, s55, s56
    s_add_u32 s55, s55, 5120
    buffer_load_dword v100, v5, s[28:31], s55 offen offset:0 nt
    s_mul_i32 s55, s49, 61440
    s_mul_i32 s56, s50, 160
    s_add_u32 s55, s55, s56
    s_add_u32 s55, s55, 5120
    buffer_load_dword v101, v5, s[28:31], s55 offen offset:1280 nt
    v_max3_f32 v15, v56, v57, v58
    v_max3_f32 v15, v15, v59, v60
    v_max3_f32 v15, v15, v61, v62
    v_max3_f32 v15, v15, v63, v64
    v_max3_f32 v15, v15, v65, v66
    v_max3_f32 v15, v15, v67, v68
    v_max3_f32 v15, v15, v69, v70
    v_max_f32 v15, v15, v71
    s_nop 1
    v_max_f32_dpp v12, v15, v15 row_ror:8 row_mask:0xf bank_mask:0xf
    s_nop 0
    v_readlane_b32 s64, v12, 0
    v_readlane_b32 s65, v12, 16
    v_readlane_b32 s66, v12, 32
    v_readlane_b32 s67, v12, 48
    v_mov_b32 v104, s64
    v_max_f32 v104, s65, v104
    v_max_f32 v104, s66, v104
    v_max_f32 v104, s67, v104
    v_mul_f32 v16, s57, v104
    v_mov_b32 v105, 0
    v_fma_f32 v56, v56, s57, -v16
    v_fma_f32 v57, v57, s57, -v16
    v_fma_f32 v58, v58, s57, -v16
    v_fma_f32 v59, v59, s57, -v16
    v_fma_f32 v60, v60, s57, -v16
    v_fma_f32 v61, v61, s57, -v16
    v_fma_f32 v62, v62, s57, -v16
    v_fma_f32 v63, v63, s57, -v16
    v_fma_f32 v64, v64, s57, -v16
    v_fma_f32 v65, v65, s57, -v16
    v_fma_f32 v66, v66, s57, -v16
    v_fma_f32 v67, v67, s57, -v16
    v_fma_f32 v68, v68, s57, -v16
    v_fma_f32 v69, v69, s57, -v16
    v_fma_f32 v70, v70, s57, -v16
    v_fma_f32 v71, v71, s57, -v16
    v_exp_f32 v56, v56
    v_exp_f32 v57, v57
    v_exp_f32 v58, v58
    v_exp_f32 v59, v59
    v_exp_f32 v60, v60
    v_exp_f32 v61, v61
    v_exp_f32 v62, v62
    v_exp_f32 v63, v63
    v_exp_f32 v64, v64
    v_exp_f32 v65, v65
    v_exp_f32 v66, v66
    v_exp_f32 v67, v67
    v_exp_f32 v68, v68
    v_exp_f32 v69, v69
    v_exp_f32 v70, v70
    v_exp_f32 v71, v71
    v_add_f32 v105, v105, v56
    v_cvt_pk_bf16_f32 v56, v56, 0
    v_add_f32 v105, v105, v57
    v_cvt_pk_bf16_f32 v57, v57, 0
    v_add_f32 v105, v105, v58
    v_cvt_pk_bf16_f32 v58, v58, 0
    v_add_f32 v105, v105, v59
    v_cvt_pk_bf16_f32 v59, v59, 0
    v_add_f32 v105, v105, v60
    v_cvt_pk_bf16_f32 v60, v60, 0
    v_add_f32 v105, v105, v61
    v_cvt_pk_bf16_f32 v61, v61, 0
    v_add_f32 v105, v105, v62
    v_cvt_pk_bf16_f32 v62, v62, 0
    v_add_f32 v105, v105, v63
    v_cvt_pk_bf16_f32 v63, v63, 0
    v_add_f32 v105, v105, v64
    v_cvt_pk_bf16_f32 v64, v64, 0
    v_add_f32 v105, v105, v65
    v_cvt_pk_bf16_f32 v65, v65, 0
    v_add_f32 v105, v105, v66
    v_cvt_pk_bf16_f32 v66, v66, 0
    v_add_f32 v105, v105, v67
    v_cvt_pk_bf16_f32 v67, v67, 0
    v_add_f32 v105, v105, v68
    v_cvt_pk_bf16_f32 v68, v68, 0
    v_add_f32 v105, v105, v69
    v_cvt_pk_bf16_f32 v69, v69, 0
    v_add_f32 v105, v105, v70
    v_cvt_pk_bf16_f32 v70, v70, 0
    v_add_f32 v105, v105, v71
    v_cvt_pk_bf16_f32 v71, v71, 0
    s_waitcnt vmcnt(37)
    v_lshlrev_b32 v102, 16, v56
    v_dot2c_f32_bf16 v20, v164, v56
    v_dot2c_f32_bf16 v22, v165, v56
    v_dot2c_f32_bf16 v24, v166, v56
    v_dot2c_f32_bf16 v26, v167, v56
    v_dot2c_f32_bf16 v28, v168, v56
    v_dot2c_f32_bf16 v30, v169, v56
    v_dot2c_f32_bf16 v32, v170, v56
    v_dot2c_f32_bf16 v34, v171, v56
    v_dot2c_f32_bf16 v36, v172, v56
    v_dot2c_f32_bf16 v38, v173, v56
    v_dot2c_f32_bf16 v40, v174, v56
    v_dot2c_f32_bf16 v42, v175, v56
    v_dot2c_f32_bf16 v21, v164, v102
    v_dot2c_f32_bf16 v23, v165, v102
    v_dot2c_f32_bf16 v25, v166, v102
    v_dot2c_f32_bf16 v27, v167, v102
    v_dot2c_f32_bf16 v29, v168, v102
    v_dot2c_f32_bf16 v31, v169, v102
    v_dot2c_f32_bf16 v33, v170, v102
    v_dot2c_f32_bf16 v35, v171, v102
    v_dot2c_f32_bf16 v37, v172, v102
    v_dot2c_f32_bf16 v39, v173, v102
    v_dot2c_f32_bf16 v41, v174, v102
    v_dot2c_f32_bf16 v43, v175, v102
    s_add_u32 s52, s51, 196608
    buffer_load_dwordx4 v[164:167], v1, s[12:15], s52 offen offset:0 nt
    buffer_load_dwordx4 v[168:171], v1, s[12:15], s52 offen offset:128 nt
    buffer_load_dwordx4 v[172:175], v1, s[12:15], s52 offen offset:256 nt
    s_waitcnt vmcnt(35)
    v_lshlrev_b32 v102, 16, v57
    v_dot2c_f32_bf16 v20, v176, v57
    v_dot2c_f32_bf16 v22, v177, v57
    v_dot2c_f32_bf16 v24, v178, v57
    v_dot2c_f32_bf16 v26, v179, v57
    v_dot2c_f32_bf16 v28, v180, v57
    v_dot2c_f32_bf16 v30, v181, v57
    v_dot2c_f32_bf16 v32, v182, v57
    v_dot2c_f32_bf16 v34, v183, v57
    v_dot2c_f32_bf16 v36, v184, v57
    v_dot2c_f32_bf16 v38, v185, v57
    v_dot2c_f32_bf16 v40, v186, v57
    v_dot2c_f32_bf16 v42, v187, v57
    v_dot2c_f32_bf16 v21, v176, v102
    v_dot2c_f32_bf16 v23, v177, v102
    v_dot2c_f32_bf16 v25, v178, v102
    v_dot2c_f32_bf16 v27, v179, v102
    v_dot2c_f32_bf16 v29, v180, v102
    v_dot2c_f32_bf16 v31, v181, v102
    v_dot2c_f32_bf16 v33, v182, v102
    v_dot2c_f32_bf16 v35, v183, v102
    v_dot2c_f32_bf16 v37, v184, v102
    v_dot2c_f32_bf16 v39, v185, v102
    v_dot2c_f32_bf16 v41, v186, v102
    v_dot2c_f32_bf16 v43, v187, v102
    s_add_u32 s52, s51, 221184
    buffer_load_dwordx4 v[176:179], v1, s[12:15], s52 offen offset:0 nt
    buffer_load_dwordx4 v[180:183], v1, s[12:15], s52 offen offset:128 nt
    buffer_load_dwordx4 v[184:187], v1, s[12:15], s52 offen offset:256 nt
    s_waitcnt vmcnt(33)
    v_lshlrev_b32 v102, 16, v58
    v_dot2c_f32_bf16 v20, v188, v58
    v_dot2c_f32_bf16 v22, v189, v58
    v_dot2c_f32_bf16 v24, v190, v58
    v_dot2c_f32_bf16 v26, v191, v58
    v_dot2c_f32_bf16 v28, v192, v58
    v_dot2c_f32_bf16 v30, v193, v58
    v_dot2c_f32_bf16 v32, v194, v58
    v_dot2c_f32_bf16 v34, v195, v58
    v_dot2c_f32_bf16 v36, v196, v58
    v_dot2c_f32_bf16 v38, v197, v58
    v_dot2c_f32_bf16 v40, v198, v58
    v_dot2c_f32_bf16 v42, v199, v58
    v_dot2c_f32_bf16 v21, v188, v102
    v_dot2c_f32_bf16 v23, v189, v102
    v_dot2c_f32_bf16 v25, v190, v102
    v_dot2c_f32_bf16 v27, v191, v102
    v_dot2c_f32_bf16 v29, v192, v102
    v_dot2c_f32_bf16 v31, v193, v102
    v_dot2c_f32_bf16 v33, v194, v102
    v_dot2c_f32_bf16 v35, v195, v102
    v_dot2c_f32_bf16 v37, v196, v102
    v_dot2c_f32_bf16 v39, v197, v102
    v_dot2c_f32_bf16 v41, v198, v102
    v_dot2c_f32_bf16 v43, v199, v102
    s_add_u32 s52, s51, 245760
    buffer_load_dwordx4 v[188:191], v1, s[12:15], s52 offen offset:0 nt
    buffer_load_dwordx4 v[192:195], v1, s[12:15], s52 offen offset:128 nt
    buffer_load_dwordx4 v[196:199], v1, s[12:15], s52 offen offset:256 nt
    s_waitcnt vmcnt(31)
    v_lshlrev_b32 v102, 16, v59
    v_dot2c_f32_bf16 v20, v200, v59
    v_dot2c_f32_bf16 v22, v201, v59
    v_dot2c_f32_bf16 v24, v202, v59
    v_dot2c_f32_bf16 v26, v203, v59
    v_dot2c_f32_bf16 v28, v204, v59
    v_dot2c_f32_bf16 v30, v205, v59
    v_dot2c_f32_bf16 v32, v206, v59
    v_dot2c_f32_bf16 v34, v207, v59
    v_dot2c_f32_bf16 v36, v208, v59
    v_dot2c_f32_bf16 v38, v209, v59
    v_dot2c_f32_bf16 v40, v210, v59
    v_dot2c_f32_bf16 v42, v211, v59
    v_dot2c_f32_bf16 v21, v200, v102
    v_dot2c_f32_bf16 v23, v201, v102
    v_dot2c_f32_bf16 v25, v202, v102
    v_dot2c_f32_bf16 v27, v203, v102
    v_dot2c_f32_bf16 v29, v204, v102
    v_dot2c_f32_bf16 v31, v205, v102
    v_dot2c_f32_bf16 v33, v206, v102
    v_dot2c_f32_bf16 v35, v207, v102
    v_dot2c_f32_bf16 v37, v208, v102
    v_dot2c_f32_bf16 v39, v209, v102
    v_dot2c_f32_bf16 v41, v210, v102
    v_dot2c_f32_bf16 v43, v211, v102
    s_add_u32 s52, s51, 270336
    buffer_load_dwordx4 v[200:203], v1, s[12:15], s52 offen offset:0 nt
    buffer_load_dwordx4 v[204:207], v1, s[12:15], s52 offen offset:128 nt
    buffer_load_dwordx4 v[208:211], v1, s[12:15], s52 offen offset:256 nt
    s_cmp_eq_u32 s48, 1
    s_cbranch_scc0 L_C2_SKIP
    s_waitcnt vmcnt(37)
    s_mov_b32 exec_lo, -1
    s_mov_b32 exec_hi, 0xffff
    v_max3_u32 v138, v106, v107, v108
    v_max3_u32 v138, v138, v109, v110
    v_max3_u32 v138, v138, v111, v112
    v_max3_u32 v138, v138, v113, v114
    v_max3_u32 v138, v138, v115, v116
    v_max3_u32 v138, v138, v117, v118
    v_max3_u32 v138, v138, v119, v120
    v_max3_u32 v138, v138, v121, v122
    v_max3_u32 v138, v138, v123, v124
    v_max3_u32 v138, v138, v125, v126
    v_max3_u32 v138, v138, v127, v128
    v_max3_u32 v138, v138, v129, v130
    v_max3_u32 v138, v138, v131, v132
    v_max3_u32 v138, v138, v133, v134
    v_max3_u32 v138, v138, v135, v136
    v_max_u32 v138, v138, v137
    v_cmp_eq_u32 vcc, -1, v138
    s_cbranch_vccz L_C2_GO
    s_mov_b32 s58, 400000
L_PF_LOOP:
    s_nop 4
    s_lshr_b32 s55, s49, 2
    s_mul_i32 s55, s55, 12288
    s_and_b32 s56, s49, 3
    s_mul_i32 s56, s56, 192
    s_add_u32 s55, s55, s56
    s_add_u32 s55, s55, 0
    s_add_u32 s56, s55, 0
    buffer_load_dword v106, v139, s[44:47], s56 offen offset:0 sc1
    buffer_load_dword v107, v139, s[44:47], s56 offen offset:768 sc1
    buffer_load_dword v108, v139, s[44:47], s56 offen offset:1536 sc1
    buffer_load_dword v109, v139, s[44:47], s56 offen offset:2304 sc1
    s_add_u32 s56, s55, 3072
    buffer_load_dword v110, v139, s[44:47], s56 offen offset:0 sc1
    buffer_load_dword v111, v139, s[44:47], s56 offen offset:768 sc1
    buffer_load_dword v112, v139, s[44:47], s56 offen offset:1536 sc1
    buffer_load_dword v113, v139, s[44:47], s56 offen offset:2304 sc1
    s_add_u32 s56, s55, 6144
    buffer_load_dword v114, v139, s[44:47], s56 offen offset:0 sc1
    buffer_load_dword v115, v139, s[44:47], s56 offen offset:768 sc1
    buffer_load_dword v116, v139, s[44:47], s56 offen offset:1536 sc1
    buffer_load_dword v117, v139, s[44:47], s56 offen offset:2304 sc1
    s_add_u32 s56, s55, 9216
    buffer_load_dword v118, v139, s[44:47], s56 offen offset:0 sc1
    buffer_load_dword v119, v139, s[44:47], s56 offen offset:768 sc1
    buffer_load_dword v120, v139, s[44:47], s56 offen offset:1536 sc1
    buffer_load_dword v121, v139, s[44:47], s56 offen offset:2304 sc1
    s_add_u32 s56, s55, 98304
    buffer_load_dword v122, v139, s[44:47], s56 offen offset:0 sc1
    buffer_load_dword v123, v139, s[44:47], s56 offen offset:768 sc1
    buffer_load_dword v124, v139, s[44:47], s56 offen offset:1536 sc1
    buffer_load_dword v125, v139, s[44:47], s56 offen offset:2304 sc1
    s_add_u32 s56, s55, 101376
    buffer_load_dword v126, v139, s[44:47], s56 offen offset:0 sc1
    buffer_load_dword v127, v139, s[44:47], s56 offen offset:768 sc1
    buffer_load_dword v128, v139, s[44:47], s56 offen offset:1536 sc1
    buffer_load_dword v129, v139, s[44:47], s56 offen offset:2304 sc1
    s_add_u32 s56, s55, 104448
    buffer_load_dword v130, v139, s[44:47], s56 offen offset:0 sc1
    buffer_load_dword v131, v139, s[44:47], s56 offen offset:768 sc1
    buffer_load_dword v132, v139, s[44:47], s56 offen offset:1536 sc1
    buffer_load_dword v133, v139, s[44:47], s56 offen offset:2304 sc1
    s_add_u32 s56, s55, 107520
    buffer_load_dword v134, v139, s[44:47], s56 offen offset:0 sc1
    buffer_load_dword v135, v139, s[44:47], s56 offen offset:768 sc1
    buffer_load_dword v136, v139, s[44:47], s56 offen offset:1536 sc1
    buffer_load_dword v137, v139, s[44:47], s56 offen offset:2304 sc1
    s_waitcnt vmcnt(0)
    v_max3_u32 v138, v106, v107, v108
    v_max3_u32 v138, v138, v109, v110
    v_max3_u32 v138, v138, v111, v112
    v_max3_u32 v138, v138, v113, v114
    v_max3_u32 v138, v138, v115, v116
    v_max3_u32 v138, v138, v117, v118
    v_max3_u32 v138, v138, v119, v120
    v_max3_u32 v138, v138, v121, v122
    v_max3_u32 v138, v138, v123, v124
    v_max3_u32 v138, v138, v125, v126
    v_max3_u32 v138, v138, v127, v128
    v_max3_u32 v138, v138, v129, v130
    v_max3_u32 v138, v138, v131, v132
    v_max3_u32 v138, v138, v133, v134
    v_max3_u32 v138, v138, v135, v136
    v_max_u32 v138, v138, v137
    v_cmp_eq_u32 vcc, -1, v138
    s_cbranch_vccz L_PF_DONE
    s_sub_u32 s58, s58, 1
    s_cmp_eq_u32 s58, 0
    s_cbranch_scc1 L_PF_DONE
    s_sleep 2
    s_branch L_PF_LOOP
L_PF_DONE:
    s_nop 4
L_C2_GO:
    s_nop 4
    v_add_f32 v106, v106, v107
    v_add_f32 v122, v122, v123
    v_add_f32 v106, v106, v108
    v_add_f32 v122, v122, v124
    v_add_f32 v106, v106, v109
    v_add_f32 v122, v122, v125
    v_add_f32 v106, v106, v110
    v_add_f32 v122, v122, v126
    v_add_f32 v106, v106, v111
    v_add_f32 v122, v122, v127
    v_add_f32 v106, v106, v112
    v_add_f32 v122, v122, v128
    v_add_f32 v106, v106, v113
    v_add_f32 v122, v122, v129
    v_add_f32 v106, v106, v114
    v_add_f32 v122, v122, v130
    v_add_f32 v106, v106, v115
    v_add_f32 v122, v122, v131
    v_add_f32 v106, v106, v116
    v_add_f32 v122, v122, v132
    v_add_f32 v106, v106, v117
    v_add_f32 v122, v122, v133
    v_add_f32 v106, v106, v118
    v_add_f32 v122, v122, v134
    v_add_f32 v106, v106, v119
    v_add_f32 v122, v122, v135
    v_add_f32 v106, v106, v120
    v_add_f32 v122, v122, v136
    v_add_f32 v106, v106, v121
    v_add_f32 v122, v122, v137
    v_cvt_pk_bf16_f32 v106, v106, 0
    v_lshlrev_b32 v106, 16, v106
    v_cvt_pk_bf16_f32 v122, v122, 0
    v_lshlrev_b32 v122, 16, v122
    v_mul_f32 v107, 0xbfb8aa3b, v106
    v_exp_f32 v107, v107
    s_nop 0
    v_add_f32 v107, 1.0, v107
    v_rcp_f32 v107, v107
    s_nop 0
    v_mul_f32 v107, v106, v107
    v_cvt_pk_bf16_f32 v107, v107, 0
    v_lshlrev_b32 v107, 16, v107
    v_mul_f32 v107, v107, v122
    v_cvt_pk_bf16_f32 v107, v107, 0
    v_lshlrev_b32 v107, 16, v107
    ds_write_b32 v139, v107 offset:13696
    s_mov_b64 exec, -1
L_C2_SKIP:
    s_nop 4
    s_waitcnt vmcnt(29)
    v_lshlrev_b32 v102, 16, v60
    v_dot2c_f32_bf16 v20, v212, v60
    v_dot2c_f32_bf16 v22, v213, v60
    v_dot2c_f32_bf16 v24, v214, v60
    v_dot2c_f32_bf16 v26, v215, v60
    v_dot2c_f32_bf16 v28, v216, v60
    v_dot2c_f32_bf16 v30, v217, v60
    v_dot2c_f32_bf16 v32, v218, v60
    v_dot2c_f32_bf16 v34, v219, v60
    v_dot2c_f32_bf16 v36, v220, v60
    v_dot2c_f32_bf16 v38, v221, v60
    v_dot2c_f32_bf16 v40, v222, v60
    v_dot2c_f32_bf16 v42, v223, v60
    v_dot2c_f32_bf16 v21, v212, v102
    v_dot2c_f32_bf16 v23, v213, v102
    v_dot2c_f32_bf16 v25, v214, v102
    v_dot2c_f32_bf16 v27, v215, v102
    v_dot2c_f32_bf16 v29, v216, v102
    v_dot2c_f32_bf16 v31, v217, v102
    v_dot2c_f32_bf16 v33, v218, v102
    v_dot2c_f32_bf16 v35, v219, v102
    v_dot2c_f32_bf16 v37, v220, v102
    v_dot2c_f32_bf16 v39, v221, v102
    v_dot2c_f32_bf16 v41, v222, v102
    v_dot2c_f32_bf16 v43, v223, v102
    s_add_u32 s52, s51, 294912
    buffer_load_dwordx4 v[212:215], v1, s[12:15], s52 offen offset:0 nt
    buffer_load_dwordx4 v[216:219], v1, s[12:15], s52 offen offset:128 nt
    buffer_load_dwordx4 v[220:223], v1, s[12:15], s52 offen offset:256 nt
    s_waitcnt vmcnt(27)
    v_lshlrev_b32 v102, 16, v61
    v_dot2c_f32_bf16 v20, v224, v61
    v_dot2c_f32_bf16 v22, v225, v61
    v_dot2c_f32_bf16 v24, v226, v61
    v_dot2c_f32_bf16 v26, v227, v61
    v_dot2c_f32_bf16 v28, v228, v61
    v_dot2c_f32_bf16 v30, v229, v61
    v_dot2c_f32_bf16 v32, v230, v61
    v_dot2c_f32_bf16 v34, v231, v61
    v_dot2c_f32_bf16 v36, v232, v61
    v_dot2c_f32_bf16 v38, v233, v61
    v_dot2c_f32_bf16 v40, v234, v61
    v_dot2c_f32_bf16 v42, v235, v61
    v_dot2c_f32_bf16 v21, v224, v102
    v_dot2c_f32_bf16 v23, v225, v102
    v_dot2c_f32_bf16 v25, v226, v102
    v_dot2c_f32_bf16 v27, v227, v102
    v_dot2c_f32_bf16 v29, v228, v102
    v_dot2c_f32_bf16 v31, v229, v102
    v_dot2c_f32_bf16 v33, v230, v102
    v_dot2c_f32_bf16 v35, v231, v102
    v_dot2c_f32_bf16 v37, v232, v102
    v_dot2c_f32_bf16 v39, v233, v102
    v_dot2c_f32_bf16 v41, v234, v102
    v_dot2c_f32_bf16 v43, v235, v102
    s_add_u32 s52, s51, 319488
    buffer_load_dwordx4 v[224:227], v1, s[12:15], s52 offen offset:0 nt
    buffer_load_dwordx4 v[228:231], v1, s[12:15], s52 offen offset:128 nt
    buffer_load_dwordx4 v[232:235], v1, s[12:15], s52 offen offset:256 nt
    s_waitcnt vmcnt(25)
    v_lshlrev_b32 v102, 16, v62
    v_dot2c_f32_bf16 v20, v140, v62
    v_dot2c_f32_bf16 v22, v141, v62
    v_dot2c_f32_bf16 v24, v142, v62
    v_dot2c_f32_bf16 v26, v143, v62
    v_dot2c_f32_bf16 v28, v144, v62
    v_dot2c_f32_bf16 v30, v145, v62
    v_dot2c_f32_bf16 v32, v146, v62
    v_dot2c_f32_bf16 v34, v147, v62
    v_dot2c_f32_bf16 v36, v148, v62
    v_dot2c_f32_bf16 v38, v149, v62
    v_dot2c_f32_bf16 v40, v150, v62
    v_dot2c_f32_bf16 v42, v151, v62
    v_dot2c_f32_bf16 v21, v140, v102
    v_dot2c_f32_bf16 v23, v141, v102
    v_dot2c_f32_bf16 v25, v142, v102
    v_dot2c_f32_bf16 v27, v143, v102
    v_dot2c_f32_bf16 v29, v144, v102
    v_dot2c_f32_bf16 v31, v145, v102
    v_dot2c_f32_bf16 v33, v146, v102
    v_dot2c_f32_bf16 v35, v147, v102
    v_dot2c_f32_bf16 v37, v148, v102
    v_dot2c_f32_bf16 v39, v149, v102
    v_dot2c_f32_bf16 v41, v150, v102
    v_dot2c_f32_bf16 v43, v151, v102
    s_add_u32 s52, s51, 344064
    buffer_load_dwordx4 v[140:143], v1, s[12:15], s52 offen offset:0 nt
    buffer_load_dwordx4 v[144:147], v1, s[12:15], s52 offen offset:128 nt
    buffer_load_dwordx4 v[148:151], v1, s[12:15], s52 offen offset:256 nt
    s_waitcnt vmcnt(23)
    v_lshlrev_b32 v102, 16, v63
    v_dot2c_f32_bf16 v20, v152, v63
    v_dot2c_f32_bf16 v22, v153, v63
    v_dot2c_f32_bf16 v24, v154, v63
    v_dot2c_f32_bf16 v26, v155, v63
    v_dot2c_f32_bf16 v28, v156, v63
    v_dot2c_f32_bf16 v30, v157, v63
    v_dot2c_f32_bf16 v32, v158, v63
    v_dot2c_f32_bf16 v34, v159, v63
    v_dot2c_f32_bf16 v36, v160, v63
    v_dot2c_f32_bf16 v38, v161, v63
    v_dot2c_f32_bf16 v40, v162, v63
    v_dot2c_f32_bf16 v42, v163, v63
    v_dot2c_f32_bf16 v21, v152, v102
    v_dot2c_f32_bf16 v23, v153, v102
    v_dot2c_f32_bf16 v25, v154, v102
    v_dot2c_f32_bf16 v27, v155, v102
    v_dot2c_f32_bf16 v29, v156, v102
    v_dot2c_f32_bf16 v31, v157, v102
    v_dot2c_f32_bf16 v33, v158, v102
    v_dot2c_f32_bf16 v35, v159, v102
    v_dot2c_f32_bf16 v37, v160, v102
    v_dot2c_f32_bf16 v39, v161, v102
    v_dot2c_f32_bf16 v41, v162, v102
    v_dot2c_f32_bf16 v43, v163, v102
    s_add_u32 s52, s51, 368640
    buffer_load_dwordx4 v[152:155], v1, s[12:15], s52 offen offset:0 nt
    buffer_load_dwordx4 v[156:159], v1, s[12:15], s52 offen offset:128 nt
    buffer_load_dwordx4 v[160:163], v1, s[12:15], s52 offen offset:256 nt
    s_waitcnt vmcnt(21)
    v_lshlrev_b32 v102, 16, v64
    v_dot2c_f32_bf16 v20, v164, v64
    v_dot2c_f32_bf16 v22, v165, v64
    v_dot2c_f32_bf16 v24, v166, v64
    v_dot2c_f32_bf16 v26, v167, v64
    v_dot2c_f32_bf16 v28, v168, v64
    v_dot2c_f32_bf16 v30, v169, v64
    v_dot2c_f32_bf16 v32, v170, v64
    v_dot2c_f32_bf16 v34, v171, v64
    v_dot2c_f32_bf16 v36, v172, v64
    v_dot2c_f32_bf16 v38, v173, v64
    v_dot2c_f32_bf16 v40, v174, v64
    v_dot2c_f32_bf16 v42, v175, v64
    v_dot2c_f32_bf16 v21, v164, v102
    v_dot2c_f32_bf16 v23, v165, v102
    v_dot2c_f32_bf16 v25, v166, v102
    v_dot2c_f32_bf16 v27, v167, v102
    v_dot2c_f32_bf16 v29, v168, v102
    v_dot2c_f32_bf16 v31, v169, v102
    v_dot2c_f32_bf16 v33, v170, v102
    v_dot2c_f32_bf16 v35, v171, v102
    v_dot2c_f32_bf16 v37, v172, v102
    v_dot2c_f32_bf16 v39, v173, v102
    v_dot2c_f32_bf16 v41, v174, v102
    v_dot2c_f32_bf16 v43, v175, v102
    s_waitcnt vmcnt(18)
    v_lshlrev_b32 v102, 16, v65
    v_dot2c_f32_bf16 v20, v176, v65
    v_dot2c_f32_bf16 v22, v177, v65
    v_dot2c_f32_bf16 v24, v178, v65
    v_dot2c_f32_bf16 v26, v179, v65
    v_dot2c_f32_bf16 v28, v180, v65
    v_dot2c_f32_bf16 v30, v181, v65
    v_dot2c_f32_bf16 v32, v182, v65
    v_dot2c_f32_bf16 v34, v183, v65
    v_dot2c_f32_bf16 v36, v184, v65
    v_dot2c_f32_bf16 v38, v185, v65
    v_dot2c_f32_bf16 v40, v186, v65
    v_dot2c_f32_bf16 v42, v187, v65
    v_dot2c_f32_bf16 v21, v176, v102
    v_dot2c_f32_bf16 v23, v177, v102
    v_dot2c_f32_bf16 v25, v178, v102
    v_dot2c_f32_bf16 v27, v179, v102
    v_dot2c_f32_bf16 v29, v180, v102
    v_dot2c_f32_bf16 v31, v181, v102
    v_dot2c_f32_bf16 v33, v182, v102
    v_dot2c_f32_bf16 v35, v183, v102
    v_dot2c_f32_bf16 v37, v184, v102
    v_dot2c_f32_bf16 v39, v185, v102
    v_dot2c_f32_bf16 v41, v186, v102
    v_dot2c_f32_bf16 v43, v187, v102
    s_waitcnt vmcnt(15)
    v_lshlrev_b32 v102, 16, v66
    v_dot2c_f32_bf16 v20, v188, v66
    v_dot2c_f32_bf16 v22, v189, v66
    v_dot2c_f32_bf16 v24, v190, v66
    v_dot2c_f32_bf16 v26, v191, v66
    v_dot2c_f32_bf16 v28, v192, v66
    v_dot2c_f32_bf16 v30, v193, v66
    v_dot2c_f32_bf16 v32, v194, v66
    v_dot2c_f32_bf16 v34, v195, v66
    v_dot2c_f32_bf16 v36, v196, v66
    v_dot2c_f32_bf16 v38, v197, v66
    v_dot2c_f32_bf16 v40, v198, v66
    v_dot2c_f32_bf16 v42, v199, v66
    v_dot2c_f32_bf16 v21, v188, v102
    v_dot2c_f32_bf16 v23, v189, v102
    v_dot2c_f32_bf16 v25, v190, v102
    v_dot2c_f32_bf16 v27, v191, v102
    v_dot2c_f32_bf16 v29, v192, v102
    v_dot2c_f32_bf16 v31, v193, v102
    v_dot2c_f32_bf16 v33, v194, v102
    v_dot2c_f32_bf16 v35, v195, v102
    v_dot2c_f32_bf16 v37, v196, v102
    v_dot2c_f32_bf16 v39, v197, v102
    v_dot2c_f32_bf16 v41, v198, v102
    v_dot2c_f32_bf16 v43, v199, v102
    s_waitcnt vmcnt(12)
    v_lshlrev_b32 v102, 16, v67
    v_dot2c_f32_bf16 v20, v200, v67
    v_dot2c_f32_bf16 v22, v201, v67
    v_dot2c_f32_bf16 v24, v202, v67
    v_dot2c_f32_bf16 v26, v203, v67
    v_dot2c_f32_bf16 v28, v204, v67
    v_dot2c_f32_bf16 v30, v205, v67
    v_dot2c_f32_bf16 v32, v206, v67
    v_dot2c_f32_bf16 v34, v207, v67
    v_dot2c_f32_bf16 v36, v208, v67
    v_dot2c_f32_bf16 v38, v209, v67
    v_dot2c_f32_bf16 v40, v210, v67
    v_dot2c_f32_bf16 v42, v211, v67
    v_dot2c_f32_bf16 v21, v200, v102
    v_dot2c_f32_bf16 v23, v201, v102
    v_dot2c_f32_bf16 v25, v202, v102
    v_dot2c_f32_bf16 v27, v203, v102
    v_dot2c_f32_bf16 v29, v204, v102
    v_dot2c_f32_bf16 v31, v205, v102
    v_dot2c_f32_bf16 v33, v206, v102
    v_dot2c_f32_bf16 v35, v207, v102
    v_dot2c_f32_bf16 v37, v208, v102
    v_dot2c_f32_bf16 v39, v209, v102
    v_dot2c_f32_bf16 v41, v210, v102
    v_dot2c_f32_bf16 v43, v211, v102
    s_waitcnt vmcnt(9)
    v_lshlrev_b32 v102, 16, v68
    v_dot2c_f32_bf16 v20, v212, v68
    v_dot2c_f32_bf16 v22, v213, v68
    v_dot2c_f32_bf16 v24, v214, v68
    v_dot2c_f32_bf16 v26, v215, v68
    v_dot2c_f32_bf16 v28, v216, v68
    v_dot2c_f32_bf16 v30, v217, v68
    v_dot2c_f32_bf16 v32, v218, v68
    v_dot2c_f32_bf16 v34, v219, v68
    v_dot2c_f32_bf16 v36, v220, v68
    v_dot2c_f32_bf16 v38, v221, v68
    v_dot2c_f32_bf16 v40, v222, v68
    v_dot2c_f32_bf16 v42, v223, v68
    v_dot2c_f32_bf16 v21, v212, v102
    v_dot2c_f32_bf16 v23, v213, v102
    v_dot2c_f32_bf16 v25, v214, v102
    v_dot2c_f32_bf16 v27, v215, v102
    v_dot2c_f32_bf16 v29, v216, v102
    v_dot2c_f32_bf16 v31, v217, v102
    v_dot2c_f32_bf16 v33, v218, v102
    v_dot2c_f32_bf16 v35, v219, v102
    v_dot2c_f32_bf16 v37, v220, v102
    v_dot2c_f32_bf16 v39, v221, v102
    v_dot2c_f32_bf16 v41, v222, v102
    v_dot2c_f32_bf16 v43, v223, v102
    s_waitcnt vmcnt(6)
    v_lshlrev_b32 v102, 16, v69
    v_dot2c_f32_bf16 v20, v224, v69
    v_dot2c_f32_bf16 v22, v225, v69
    v_dot2c_f32_bf16 v24, v226, v69
    v_dot2c_f32_bf16 v26, v227, v69
    v_dot2c_f32_bf16 v28, v228, v69
    v_dot2c_f32_bf16 v30, v229, v69
    v_dot2c_f32_bf16 v32, v230, v69
    v_dot2c_f32_bf16 v34, v231, v69
    v_dot2c_f32_bf16 v36, v232, v69
    v_dot2c_f32_bf16 v38, v233, v69
    v_dot2c_f32_bf16 v40, v234, v69
    v_dot2c_f32_bf16 v42, v235, v69
    v_dot2c_f32_bf16 v21, v224, v102
    v_dot2c_f32_bf16 v23, v225, v102
    v_dot2c_f32_bf16 v25, v226, v102
    v_dot2c_f32_bf16 v27, v227, v102
    v_dot2c_f32_bf16 v29, v228, v102
    v_dot2c_f32_bf16 v31, v229, v102
    v_dot2c_f32_bf16 v33, v230, v102
    v_dot2c_f32_bf16 v35, v231, v102
    v_dot2c_f32_bf16 v37, v232, v102
    v_dot2c_f32_bf16 v39, v233, v102
    v_dot2c_f32_bf16 v41, v234, v102
    v_dot2c_f32_bf16 v43, v235, v102
    s_waitcnt vmcnt(3)
    v_lshlrev_b32 v102, 16, v70
    v_dot2c_f32_bf16 v20, v140, v70
    v_dot2c_f32_bf16 v22, v141, v70
    v_dot2c_f32_bf16 v24, v142, v70
    v_dot2c_f32_bf16 v26, v143, v70
    v_dot2c_f32_bf16 v28, v144, v70
    v_dot2c_f32_bf16 v30, v145, v70
    v_dot2c_f32_bf16 v32, v146, v70
    v_dot2c_f32_bf16 v34, v147, v70
    v_dot2c_f32_bf16 v36, v148, v70
    v_dot2c_f32_bf16 v38, v149, v70
    v_dot2c_f32_bf16 v40, v150, v70
    v_dot2c_f32_bf16 v42, v151, v70
    v_dot2c_f32_bf16 v21, v140, v102
    v_dot2c_f32_bf16 v23, v141, v102
    v_dot2c_f32_bf16 v25, v142, v102
    v_dot2c_f32_bf16 v27, v143, v102
    v_dot2c_f32_bf16 v29, v144, v102
    v_dot2c_f32_bf16 v31, v145, v102
    v_dot2c_f32_bf16 v33, v146, v102
    v_dot2c_f32_bf16 v35, v147, v102
    v_dot2c_f32_bf16 v37, v148, v102
    v_dot2c_f32_bf16 v39, v149, v102
    v_dot2c_f32_bf16 v41, v150, v102
    v_dot2c_f32_bf16 v43, v151, v102
    s_waitcnt vmcnt(0)
    v_lshlrev_b32 v102, 16, v71
    v_dot2c_f32_bf16 v20, v152, v71
    v_dot2c_f32_bf16 v22, v153, v71
    v_dot2c_f32_bf16 v24, v154, v71
    v_dot2c_f32_bf16 v26, v155, v71
    v_dot2c_f32_bf16 v28, v156, v71
    v_dot2c_f32_bf16 v30, v157, v71
    v_dot2c_f32_bf16 v32, v158, v71
    v_dot2c_f32_bf16 v34, v159, v71
    v_dot2c_f32_bf16 v36, v160, v71
    v_dot2c_f32_bf16 v38, v161, v71
    v_dot2c_f32_bf16 v40, v162, v71
    v_dot2c_f32_bf16 v42, v163, v71
    v_dot2c_f32_bf16 v21, v152, v102
    v_dot2c_f32_bf16 v23, v153, v102
    v_dot2c_f32_bf16 v25, v154, v102
    v_dot2c_f32_bf16 v27, v155, v102
    v_dot2c_f32_bf16 v29, v156, v102
    v_dot2c_f32_bf16 v31, v157, v102
    v_dot2c_f32_bf16 v33, v158, v102
    v_dot2c_f32_bf16 v35, v159, v102
    v_dot2c_f32_bf16 v37, v160, v102
    v_dot2c_f32_bf16 v39, v161, v102
    v_dot2c_f32_bf16 v41, v162, v102
    v_dot2c_f32_bf16 v43, v163, v102
    v_add_f32_dpp v20, v20, v20 row_ror:8 row_mask:0xf bank_mask:0xf
    v_add_f32_dpp v21, v21, v21 row_ror:8 row_mask:0xf bank_mask:0xf
    v_add_f32_dpp v22, v22, v22 row_ror:8 row_mask:0xf bank_mask:0xf
    v_add_f32_dpp v23, v23, v23 row_ror:8 row_mask:0xf bank_mask:0xf
    v_add_f32_dpp v24, v24, v24 row_ror:8 row_mask:0xf bank_mask:0xf
    v_add_f32_dpp v25, v25, v25 row_ror:8 row_mask:0xf bank_mask:0xf
    v_add_f32_dpp v26, v26, v26 row_ror:8 row_mask:0xf bank_mask:0xf
    v_add_f32_dpp v27, v27, v27 row_ror:8 row_mask:0xf bank_mask:0xf
    v_add_f32_dpp v28, v28, v28 row_ror:8 row_mask:0xf bank_mask:0xf
    v_add_f32_dpp v29, v29, v29 row_ror:8 row_mask:0xf bank_mask:0xf
    v_add_f32_dpp v30, v30, v30 row_ror:8 row_mask:0xf bank_mask:0xf
    v_add_f32_dpp v31, v31, v31 row_ror:8 row_mask:0xf bank_mask:0xf
    v_add_f32_dpp v32, v32, v32 row_ror:8 row_mask:0xf bank_mask:0xf
    v_add_f32_dpp v33, v33, v33 row_ror:8 row_mask:0xf bank_mask:0xf
    v_add_f32_dpp v34, v34, v34 row_ror:8 row_mask:0xf bank_mask:0xf
    v_add_f32_dpp v35, v35, v35 row_ror:8 row_mask:0xf bank_mask:0xf
    v_add_f32_dpp v36, v36, v36 row_ror:8 row_mask:0xf bank_mask:0xf
    v_add_f32_dpp v37, v37, v37 row_ror:8 row_mask:0xf bank_mask:0xf
    v_add_f32_dpp v38, v38, v38 row_ror:8 row_mask:0xf bank_mask:0xf
    v_add_f32_dpp v39, v39, v39 row_ror:8 row_mask:0xf bank_mask:0xf
    v_add_f32_dpp v40, v40, v40 row_ror:8 row_mask:0xf bank_mask:0xf
    v_add_f32_dpp v41, v41, v41 row_ror:8 row_mask:0xf bank_mask:0xf
    v_add_f32_dpp v42, v42, v42 row_ror:8 row_mask:0xf bank_mask:0xf
    v_add_f32_dpp v43, v43, v43 row_ror:8 row_mask:0xf bank_mask:0xf
    v_permlane16_swap_b32 v20, v32
    v_permlane16_swap_b32 v21, v33
    v_permlane16_swap_b32 v22, v34
    v_permlane16_swap_b32 v23, v35
    v_permlane16_swap_b32 v24, v36
    v_permlane16_swap_b32 v25, v37
    v_permlane16_swap_b32 v26, v38
    v_permlane16_swap_b32 v27, v39
    v_permlane16_swap_b32 v28, v40
    v_permlane16_swap_b32 v29, v41
    v_permlane16_swap_b32 v30, v42
    v_permlane16_swap_b32 v31, v43
    v_add_f32 v20, v20, v32
    v_add_f32 v21, v21, v33
    v_add_f32 v22, v22, v34
    v_add_f32 v23, v23, v35
    v_add_f32 v24, v24, v36
    v_add_f32 v25, v25, v37
    v_add_f32 v26, v26, v38
    v_add_f32 v27, v27, v39
    v_add_f32 v28, v28, v40
    v_add_f32 v29, v29, v41
    v_add_f32 v30, v30, v42
    v_add_f32 v31, v31, v43
    v_permlane32_swap_b32 v20, v26
    v_permlane32_swap_b32 v21, v27
    v_permlane32_swap_b32 v22, v28
    v_permlane32_swap_b32 v23, v29
    v_permlane32_swap_b32 v24, v30
    v_permlane32_swap_b32 v25, v31
    v_add_f32 v20, v20, v26
    v_add_f32 v21, v21, v27
    v_add_f32 v22, v22, v28
    v_add_f32 v23, v23, v29
    v_add_f32 v24, v24, v30
    v_add_f32 v25, v25, v31
    ds_write_b64 v10, v[20:21] offset:6656
    ds_write_b64 v10, v[22:23] offset:6664
    ds_write_b64 v10, v[24:25] offset:6672
    v_add_f32_dpp v12, v105, v105 row_ror:8 row_mask:0xf bank_mask:0xf
    s_nop 0
    v_readlane_b32 s64, v12, 0
    v_readlane_b32 s65, v12, 16
    v_readlane_b32 s66, v12, 32
    v_readlane_b32 s67, v12, 48
    v_mov_b32 v17, s64
    v_add_f32 v17, s65, v17
    v_add_f32 v17, s66, v17
    v_add_f32 v17, s67, v17
    v_mov_b32 v16, v104
    s_lshl_b32 s55, s48, 3
    v_mov_b32 v18, s55
    ds_write_b64 v18, v[16:17] offset:12800
    s_waitcnt vmcnt(0) lgkmcnt(0)
    s_barrier
    s_cmp_eq_u32 s48, 0
    s_cbranch_scc0 L_T1_SKIP
    ds_read_b128 v[140:143], v11 offset:6656
    ds_read_b128 v[144:147], v11 offset:7424
    ds_read_b128 v[148:151], v11 offset:8192
    ds_read_b128 v[152:155], v11 offset:8960
    ds_read_b128 v[156:159], v11 offset:9728
    ds_read_b128 v[160:163], v11 offset:10496
    ds_read_b128 v[164:167], v11 offset:11264
    ds_read_b128 v[168:171], v11 offset:12032
    v_mov_b32 v12, 0
    ds_read_b128 v[172:175], v12 offset:12800
    ds_read_b128 v[176:179], v12 offset:12816
    ds_read_b128 v[180:183], v12 offset:12832
    ds_read_b128 v[184:187], v12 offset:12848
    s_waitcnt lgkmcnt(0)
    v_max_f32 v13, v172, v174
    v_max_f32 v13, v176, v13
    v_max_f32 v13, v178, v13
    v_max_f32 v13, v180, v13
    v_max_f32 v13, v182, v13
    v_max_f32 v13, v184, v13
    v_max_f32 v13, v186, v13
    v_mul_f32 v28, s57, v13
    v_fma_f32 v20, v172, s57, -v28
    v_fma_f32 v21, v174, s57, -v28
    v_fma_f32 v22, v176, s57, -v28
    v_fma_f32 v23, v178, s57, -v28
    v_fma_f32 v24, v180, s57, -v28
    v_fma_f32 v25, v182, s57, -v28
    v_fma_f32 v26, v184, s57, -v28
    v_fma_f32 v27, v186, s57, -v28
    v_exp_f32 v20, v20
    v_exp_f32 v21, v21
    v_exp_f32 v22, v22
    v_exp_f32 v23, v23
    v_exp_f32 v24, v24
    v_exp_f32 v25, v25
    v_exp_f32 v26, v26
    v_exp_f32 v27, v27
    v_mul_f32 v14, v173, v20
    v_fma_f32 v14, v175, v21, v14
    v_fma_f32 v14, v177, v22, v14
    v_fma_f32 v14, v179, v23, v14
    v_fma_f32 v14, v181, v24, v14
    v_fma_f32 v14, v183, v25, v14
    v_fma_f32 v14, v185, v26, v14
    v_fma_f32 v14, v187, v27, v14
    v_mul_f32 v140, v140, v20
    v_mul_f32 v141, v141, v20
    v_mul_f32 v142, v142, v20
    v_mul_f32 v143, v143, v20
    v_fma_f32 v140, v144, v21, v140
    v_fma_f32 v141, v145, v21, v141
    v_fma_f32 v142, v146, v21, v142
    v_fma_f32 v143, v147, v21, v143
    v_fma_f32 v140, v148, v22, v140
    v_fma_f32 v141, v149, v22, v141
    v_fma_f32 v142, v150, v22, v142
    v_fma_f32 v143, v151, v22, v143
    v_fma_f32 v140, v152, v23, v140
    v_fma_f32 v141, v153, v23, v141
    v_fma_f32 v142, v154, v23, v142
    v_fma_f32 v143, v155, v23, v143
    v_fma_f32 v140, v156, v24, v140
    v_fma_f32 v141, v157, v24, v141
    v_fma_f32 v142, v158, v24, v142
    v_fma_f32 v143, v159, v24, v143
    v_fma_f32 v140, v160, v25, v140
    v_fma_f32 v141, v161, v25, v141
    v_fma_f32 v142, v162, v25, v142
    v_fma_f32 v143, v163, v25, v143
    v_fma_f32 v140, v164, v26, v140
    v_fma_f32 v141, v165, v26, v141
    v_fma_f32 v142, v166, v26, v142
    v_fma_f32 v143, v167, v26, v143
    v_fma_f32 v140, v168, v27, v140
    v_fma_f32 v141, v169, v27, v141
    v_fma_f32 v142, v170, v27, v142
    v_fma_f32 v143, v171, v27, v143
    v_cmp_eq_u32 vcc, 48, v0
    s_nop 1
    v_cndmask_b32 v140, v140, v13, vcc
    v_cndmask_b32 v141, v141, v14, vcc
    v_cndmask_b32 v142, v142, 0, vcc
    v_cndmask_b32 v143, v143, 0, vcc
    v_mov_b32 v19, 0x7fc00000
    v_cmp_eq_u32 vcc, -1, v140
    s_nop 1
    v_cndmask_b32 v140, v140, v19, vcc
    v_cmp_eq_u32 vcc, -1, v141
    s_nop 1
    v_cndmask_b32 v141, v141, v19, vcc
    v_cmp_eq_u32 vcc, -1, v142
    s_nop 1
    v_cndmask_b32 v142, v142, v19, vcc
    v_cmp_eq_u32 vcc, -1, v143
    s_nop 1
    v_cndmask_b32 v143, v143, v19, vcc
    s_mov_b32 exec_lo, -1
    s_mov_b32 exec_hi, 0x1ffff
    s_lshl_b32 s55, s50, 10
    s_add_u32 s55, s55, s61
    s_add_u32 s56, s55, 1048576
    buffer_store_dwordx4 v[140:143], v11, s[44:47], s55 offen sc1
    s_add_u32 s64, s24, s61
    s_add_u32 s65, s25, s61
    s_add_u32 s66, s26, s61
    s_add_u32 s67, s27, s61
    s_add_u32 s68, s32, s61
    s_add_u32 s69, s33, s61
    s_add_u32 s70, s34, s61
    s_add_u32 s71, s35, s61
    s_mov_b32 s58, 400000
L_PA_LOOP:
    s_nop 4
    buffer_load_dwordx4 v[188:191], v11, s[44:47], s64 offen sc1
    buffer_load_dwordx4 v[192:195], v11, s[44:47], s65 offen sc1
    buffer_load_dwordx4 v[196:199], v11, s[44:47], s66 offen sc1
    buffer_load_dwordx4 v[200:203], v11, s[44:47], s67 offen sc1
    buffer_load_dwordx4 v[204:207], v11, s[44:47], s68 offen sc1
    buffer_load_dwordx4 v[208:211], v11, s[44:47], s69 offen sc1
    buffer_load_dwordx4 v[212:215], v11, s[44:47], s70 offen sc1
    buffer_load_dwordx4 v[216:219], v11, s[44:47], s71 offen sc1
    s_waitcnt vmcnt(0)
    v_max3_u32 v12, v188, v189, v190
    v_max3_u32 v12, v12, v191, v192
    v_max3_u32 v12, v12, v193, v194
    v_max3_u32 v12, v12, v195, v196
    v_max3_u32 v12, v12, v197, v198
    v_max3_u32 v12, v12, v199, v200
    v_max3_u32 v12, v12, v201, v202
    v_max3_u32 v12, v12, v203, v204
    v_max3_u32 v12, v12, v205, v206
    v_max3_u32 v12, v12, v207, v208
    v_max3_u32 v12, v12, v209, v210
    v_max3_u32 v12, v12, v211, v212
    v_max3_u32 v12, v12, v213, v214
    v_max3_u32 v12, v12, v215, v216
    v_max3_u32 v12, v12, v217, v218
    v_max_u32 v12, v12, v219
    v_cmp_eq_u32 vcc, -1, v12
    s_cbranch_vccz L_PA_DONE
    s_sub_u32 s58, s58, 1
    s_cmp_eq_u32 s58, 0
    s_cbranch_scc1 L_PA_DONE
    s_branch L_PA_LOOP
L_PA_DONE:
    s_nop 4
    v_readlane_b32 s64, v188, 48
    v_readlane_b32 s65, v189, 48
    v_readlane_b32 s66, v192, 48
    v_readlane_b32 s67, v193, 48
    v_readlane_b32 s68, v196, 48
    v_readlane_b32 s69, v197, 48
    v_readlane_b32 s70, v200, 48
    v_readlane_b32 s71, v201, 48
    v_readlane_b32 s72, v204, 48
    v_readlane_b32 s73, v205, 48
    v_readlane_b32 s74, v208, 48
    v_readlane_b32 s75, v209, 48
    v_readlane_b32 s76, v212, 48
    v_readlane_b32 s77, v213, 48
    v_readlane_b32 s78, v216, 48
    v_readlane_b32 s79, v217, 48
    v_mov_b32 v13, s64
    v_max_f32 v13, s66, v13
    v_max_f32 v13, s68, v13
    v_max_f32 v13, s70, v13
    v_max_f32 v13, s72, v13
    v_max_f32 v13, s74, v13
    v_max_f32 v13, s76, v13
    v_max_f32 v13, s78, v13
    v_mul_f32 v28, s57, v13
    v_mov_b32 v20, s64
    v_fma_f32 v20, v20, s57, -v28
    v_mov_b32 v21, s66
    v_fma_f32 v21, v21, s57, -v28
    v_mov_b32 v22, s68
    v_fma_f32 v22, v22, s57, -v28
    v_mov_b32 v23, s70
    v_fma_f32 v23, v23, s57, -v28
    v_mov_b32 v24, s72
    v_fma_f32 v24, v24, s57, -v28
    v_mov_b32 v25, s74
    v_fma_f32 v25, v25, s57, -v28
    v_mov_b32 v26, s76
    v_fma_f32 v26, v26, s57, -v28
    v_mov_b32 v27, s78
    v_fma_f32 v27, v27, s57, -v28
    v_exp_f32 v20, v20
    v_exp_f32 v21, v21
    v_exp_f32 v22, v22
    v_exp_f32 v23, v23
    v_exp_f32 v24, v24
    v_exp_f32 v25, v25
    v_exp_f32 v26, v26
    v_exp_f32 v27, v27
    v_mul_f32 v14, s65, v20
    v_fma_f32 v14, s67, v21, v14
    v_fma_f32 v14, s69, v22, v14
    v_fma_f32 v14, s71, v23, v14
    v_fma_f32 v14, s73, v24, v14
    v_fma_f32 v14, s75, v25, v14
    v_fma_f32 v14, s77, v26, v14
    v_fma_f32 v14, s79, v27, v14
    v_mul_f32 v188, v188, v20
    v_mul_f32 v189, v189, v20
    v_mul_f32 v190, v190, v20
    v_mul_f32 v191, v191, v20
    v_fma_f32 v188, v192, v21, v188
    v_fma_f32 v189, v193, v21, v189
    v_fma_f32 v190, v194, v21, v190
    v_fma_f32 v191, v195, v21, v191
    v_fma_f32 v188, v196, v22, v188
    v_fma_f32 v189, v197, v22, v189
    v_fma_f32 v190, v198, v22, v190
    v_fma_f32 v191, v199, v22, v191
    v_fma_f32 v188, v200, v23, v188
    v_fma_f32 v189, v201, v23, v189
    v_fma_f32 v190, v202, v23, v190
    v_fma_f32 v191, v203, v23, v191
    v_fma_f32 v188, v204, v24, v188
    v_fma_f32 v189, v205, v24, v189
    v_fma_f32 v190, v206, v24, v190
    v_fma_f32 v191, v207, v24, v191
    v_fma_f32 v188, v208, v25, v188
    v_fma_f32 v189, v209, v25, v189
    v_fma_f32 v190, v210, v25, v190
    v_fma_f32 v191, v211, v25, v191
    v_fma_f32 v188, v212, v26, v188
    v_fma_f32 v189, v213, v26, v189
    v_fma_f32 v190, v214, v26, v190
    v_fma_f32 v191, v215, v26, v191
    v_fma_f32 v188, v216, v27, v188
    v_fma_f32 v189, v217, v27, v189
    v_fma_f32 v190, v218, v27, v190
    v_fma_f32 v191, v219, v27, v191
    v_rcp_f32 v14, v14
    s_mov_b32 exec_lo, -1
    s_mov_b32 exec_hi, 0xffff
    v_mul_f32 v188, v188, v14
    v_mul_f32 v189, v189, v14
    v_mul_f32 v190, v190, v14
    v_mul_f32 v191, v191, v14
    v_cvt_pk_bf16_f32 v188, v188, 0
    v_lshlrev_b32 v188, 16, v188
    v_lshlrev_b32 v192, 2, v6
    v_cvt_pk_bf16_f32 v189, v189, 0
    v_lshlrev_b32 v189, 16, v189
    v_lshlrev_b32 v193, 2, v7
    v_cvt_pk_bf16_f32 v190, v190, 0
    v_lshlrev_b32 v190, 16, v190
    v_lshlrev_b32 v194, 2, v8
    v_cvt_pk_bf16_f32 v191, v191, 0
    v_lshlrev_b32 v191, 16, v191
    v_lshlrev_b32 v195, 2, v9
    ds_write_b32 v192, v188 offset:12928
    ds_write_b32 v193, v189 offset:12928
    ds_write_b32 v194, v190 offset:12928
    ds_write_b32 v195, v191 offset:12928
    s_mov_b64 exec, -1
    s_waitcnt lgkmcnt(0)
L_T1_SKIP:
    s_nop 4
    s_barrier
    s_mul_i32 s55, s48, 96
    v_mov_b32 v12, s55
    ds_read_b128 v[140:143], v12 offset:12928
    ds_read_b128 v[144:147], v12 offset:12944
    ds_read_b128 v[148:151], v12 offset:12960
    ds_read_b128 v[152:155], v12 offset:12976
    ds_read_b128 v[156:159], v12 offset:12992
    ds_read_b128 v[160:163], v12 offset:13008
    s_mul_i32 s55, s48, 24
    v_mov_b32 v13, s55
    ds_read_b64 v[164:165], v13 offset:13696
    ds_read_b64 v[166:167], v13 offset:13704
    ds_read_b64 v[168:169], v13 offset:13712
    v_mov_b32 v20, 0
    v_mov_b32 v21, 0
    v_mov_b32 v22, 0
    v_mov_b32 v23, 0
    s_waitcnt lgkmcnt(0)
    v_lshlrev_b32 v14, 16, v72
    v_and_b32 v15, 0xffff0000, v72
    v_fmac_f32 v20, v140, v14
    v_fmac_f32 v21, v140, v15
    v_lshlrev_b32 v16, 16, v73
    v_and_b32 v17, 0xffff0000, v73
    v_fmac_f32 v20, v141, v16
    v_fmac_f32 v21, v141, v17
    v_lshlrev_b32 v14, 16, v74
    v_and_b32 v15, 0xffff0000, v74
    v_fmac_f32 v20, v142, v14
    v_fmac_f32 v21, v142, v15
    v_lshlrev_b32 v16, 16, v75
    v_and_b32 v17, 0xffff0000, v75
    v_fmac_f32 v20, v143, v16
    v_fmac_f32 v21, v143, v17
    v_lshlrev_b32 v14, 16, v76
    v_and_b32 v15, 0xffff0000, v76
    v_fmac_f32 v20, v144, v14
    v_fmac_f32 v21, v144, v15
    v_lshlrev_b32 v16, 16, v77
    v_and_b32 v17, 0xffff0000, v77
    v_fmac_f32 v20, v145, v16
    v_fmac_f32 v21, v145, v17
    v_lshlrev_b32 v14, 16, v78
    v_and_b32 v15, 0xffff0000, v78
    v_fmac_f32 v20, v146, v14
    v_fmac_f32 v21, v146, v15
    v_lshlrev_b32 v16, 16, v79
    v_and_b32 v17, 0xffff0000, v79
    v_fmac_f32 v20, v147, v16
    v_fmac_f32 v21, v147, v17
    v_lshlrev_b32 v14, 16, v80
    v_and_b32 v15, 0xffff0000, v80
    v_fmac_f32 v20, v148, v14
    v_fmac_f32 v21, v148, v15
    v_lshlrev_b32 v16, 16, v81
    v_and_b32 v17, 0xffff0000, v81
    v_fmac_f32 v20, v149, v16
    v_fmac_f32 v21, v149, v17
    v_lshlrev_b32 v14, 16, v82
    v_and_b32 v15, 0xffff0000, v82
    v_fmac_f32 v20, v150, v14
    v_fmac_f32 v21, v150, v15
    v_lshlrev_b32 v16, 16, v83
    v_and_b32 v17, 0xffff0000, v83
    v_fmac_f32 v20, v151, v16
    v_fmac_f32 v21, v151, v17
    v_lshlrev_b32 v14, 16, v84
    v_and_b32 v15, 0xffff0000, v84
    v_fmac_f32 v20, v152, v14
    v_fmac_f32 v21, v152, v15
    v_lshlrev_b32 v16, 16, v85
    v_and_b32 v17, 0xffff0000, v85
    v_fmac_f32 v20, v153, v16
    v_fmac_f32 v21, v153, v17
    v_lshlrev_b32 v14, 16, v86
    v_and_b32 v15, 0xffff0000, v86
    v_fmac_f32 v20, v154, v14
    v_fmac_f32 v21, v154, v15
    v_lshlrev_b32 v16, 16, v87
    v_and_b32 v17, 0xffff0000, v87
    v_fmac_f32 v20, v155, v16
    v_fmac_f32 v21, v155, v17
    v_lshlrev_b32 v14, 16, v88
    v_and_b32 v15, 0xffff0000, v88
    v_fmac_f32 v20, v156, v14
    v_fmac_f32 v21, v156, v15
    v_lshlrev_b32 v16, 16, v89
    v_and_b32 v17, 0xffff0000, v89
    v_fmac_f32 v20, v157, v16
    v_fmac_f32 v21, v157, v17
    v_lshlrev_b32 v14, 16, v90
    v_and_b32 v15, 0xffff0000, v90
    v_fmac_f32 v20, v158, v14
    v_fmac_f32 v21, v158, v15
    v_lshlrev_b32 v16, 16, v91
    v_and_b32 v17, 0xffff0000, v91
    v_fmac_f32 v20, v159, v16
    v_fmac_f32 v21, v159, v17
    v_lshlrev_b32 v14, 16, v92
    v_and_b32 v15, 0xffff0000, v92
    v_fmac_f32 v20, v160, v14
    v_fmac_f32 v21, v160, v15
    v_lshlrev_b32 v16, 16, v93
    v_and_b32 v17, 0xffff0000, v93
    v_fmac_f32 v20, v161, v16
    v_fmac_f32 v21, v161, v17
    v_lshlrev_b32 v14, 16, v94
    v_and_b32 v15, 0xffff0000, v94
    v_fmac_f32 v20, v162, v14
    v_fmac_f32 v21, v162, v15
    v_lshlrev_b32 v16, 16, v95
    v_and_b32 v17, 0xffff0000, v95
    v_fmac_f32 v20, v163, v16
    v_fmac_f32 v21, v163, v17
    v_lshlrev_b32 v14, 16, v96
    v_and_b32 v15, 0xffff0000, v96
    v_fmac_f32 v22, v164, v14
    v_fmac_f32 v23, v164, v15
    v_lshlrev_b32 v16, 16, v97
    v_and_b32 v17, 0xffff0000, v97
    v_fmac_f32 v22, v165, v16
    v_fmac_f32 v23, v165, v17
    v_lshlrev_b32 v14, 16, v98
    v_and_b32 v15, 0xffff0000, v98
    v_fmac_f32 v22, v166, v14
    v_fmac_f32 v23, v166, v15
    v_lshlrev_b32 v16, 16, v99
    v_and_b32 v17, 0xffff0000, v99
    v_fmac_f32 v22, v167, v16
    v_fmac_f32 v23, v167, v17
    v_lshlrev_b32 v14, 16, v100
    v_and_b32 v15, 0xffff0000, v100
    v_fmac_f32 v22, v168, v14
    v_fmac_f32 v23, v168, v15
    v_lshlrev_b32 v16, 16, v101
    v_and_b32 v17, 0xffff0000, v101
    v_fmac_f32 v22, v169, v16
    v_fmac_f32 v23, v169, v17
    s_mul_i32 s55, s48, 640
    v_add_u32 v12, s55, v11
    s_mov_b32 exec_lo, -1
    s_mov_b32 exec_hi, 0xff
    ds_write_b128 v12, v[20:23] offset:14336
    s_mov_b64 exec, -1
    s_waitcnt lgkmcnt(0)
    s_barrier
    s_cmp_eq_u32 s48, 0
    s_cbranch_scc0 L_END
    s_mov_b32 exec_lo, -1
    s_mov_b32 exec_hi, 0xff
    ds_read_b128 v[140:143], v11 offset:14336
    ds_read_b128 v[144:147], v11 offset:14976
    ds_read_b128 v[148:151], v11 offset:15616
    ds_read_b128 v[152:155], v11 offset:16256
    ds_read_b128 v[156:159], v11 offset:16896
    ds_read_b128 v[160:163], v11 offset:17536
    ds_read_b128 v[164:167], v11 offset:18176
    ds_read_b128 v[168:171], v11 offset:18816
    v_mov_b32 v12, 0
    ds_read_b32 v13, v12 offset:13888
    s_waitcnt lgkmcnt(0)
    v_add_f32 v140, v140, v144
    v_add_f32 v141, v141, v145
    v_add_f32 v142, v142, v146
    v_add_f32 v143, v143, v147
    v_add_f32 v140, v140, v148
    v_add_f32 v141, v141, v149
    v_add_f32 v142, v142, v150
    v_add_f32 v143, v143, v151
    v_add_f32 v140, v140, v152
    v_add_f32 v141, v141, v153
    v_add_f32 v142, v142, v154
    v_add_f32 v143, v143, v155
    v_add_f32 v140, v140, v156
    v_add_f32 v141, v141, v157
    v_add_f32 v142, v142, v158
    v_add_f32 v143, v143, v159
    v_add_f32 v140, v140, v160
    v_add_f32 v141, v141, v161
    v_add_f32 v142, v142, v162
    v_add_f32 v143, v143, v163
    v_add_f32 v140, v140, v164
    v_add_f32 v141, v141, v165
    v_add_f32 v142, v142, v166
    v_add_f32 v143, v143, v167
    v_add_f32 v140, v140, v168
    v_add_f32 v141, v141, v169
    v_add_f32 v142, v142, v170
    v_add_f32 v143, v143, v171
    v_mov_b32 v19, 0x7fc00000
    v_cmp_eq_u32 vcc, -1, v140
    s_nop 1
    v_cndmask_b32 v140, v140, v19, vcc
    v_cmp_eq_u32 vcc, -1, v141
    s_nop 1
    v_cndmask_b32 v141, v141, v19, vcc
    v_cmp_eq_u32 vcc, -1, v142
    s_nop 1
    v_cndmask_b32 v142, v142, v19, vcc
    v_cmp_eq_u32 vcc, -1, v143
    s_nop 1
    v_cndmask_b32 v143, v143, v19, vcc
    s_mul_i32 s55, s49, 640
    s_add_u32 s55, s55, s62
    buffer_store_dwordx4 v[140:143], v11, s[44:47], s55 offen sc1
    s_lshl_b32 s55, s50, 2
    s_cmp_eq_u32 s49, s55
    s_cbranch_scc0 L_FLUSH
    s_add_u32 s64, s62, 0
    s_add_u32 s65, s62, 2560
    s_add_u32 s66, s62, 5120
    s_add_u32 s67, s62, 7680
    s_add_u32 s68, s62, 10240
    s_add_u32 s69, s62, 12800
    s_add_u32 s70, s62, 15360
    s_add_u32 s71, s62, 17920
    s_mov_b32 s58, 400000
L_PB_LOOP:
    s_nop 4
    buffer_load_dwordx4 v[72:75], v11, s[44:47], s64 offen offset:0 sc1
    buffer_load_dwordx4 v[76:79], v11, s[44:47], s64 offen offset:640 sc1
    buffer_load_dwordx4 v[80:83], v11, s[44:47], s64 offen offset:1280 sc1
    buffer_load_dwordx4 v[84:87], v11, s[44:47], s64 offen offset:1920 sc1
    buffer_load_dwordx4 v[88:91], v11, s[44:47], s65 offen offset:0 sc1
    buffer_load_dwordx4 v[92:95], v11, s[44:47], s65 offen offset:640 sc1
    buffer_load_dwordx4 v[96:99], v11, s[44:47], s65 offen offset:1280 sc1
    buffer_load_dwordx4 v[100:103], v11, s[44:47], s65 offen offset:1920 sc1
    buffer_load_dwordx4 v[104:107], v11, s[44:47], s66 offen offset:0 sc1
    buffer_load_dwordx4 v[108:111], v11, s[44:47], s66 offen offset:640 sc1
    buffer_load_dwordx4 v[112:115], v11, s[44:47], s66 offen offset:1280 sc1
    buffer_load_dwordx4 v[116:119], v11, s[44:47], s66 offen offset:1920 sc1
    buffer_load_dwordx4 v[120:123], v11, s[44:47], s67 offen offset:0 sc1
    buffer_load_dwordx4 v[124:127], v11, s[44:47], s67 offen offset:640 sc1
    buffer_load_dwordx4 v[128:131], v11, s[44:47], s67 offen offset:1280 sc1
    buffer_load_dwordx4 v[132:135], v11, s[44:47], s67 offen offset:1920 sc1
    buffer_load_dwordx4 v[136:139], v11, s[44:47], s68 offen offset:0 sc1
    buffer_load_dwordx4 v[140:143], v11, s[44:47], s68 offen offset:640 sc1
    buffer_load_dwordx4 v[144:147], v11, s[44:47], s68 offen offset:1280 sc1
    buffer_load_dwordx4 v[148:151], v11, s[44:47], s68 offen offset:1920 sc1
    buffer_load_dwordx4 v[152:155], v11, s[44:47], s69 offen offset:0 sc1
    buffer_load_dwordx4 v[156:159], v11, s[44:47], s69 offen offset:640 sc1
    buffer_load_dwordx4 v[160:163], v11, s[44:47], s69 offen offset:1280 sc1
    buffer_load_dwordx4 v[164:167], v11, s[44:47], s69 offen offset:1920 sc1
    buffer_load_dwordx4 v[168:171], v11, s[44:47], s70 offen offset:0 sc1
    buffer_load_dwordx4 v[172:175], v11, s[44:47], s70 offen offset:640 sc1
    buffer_load_dwordx4 v[176:179], v11, s[44:47], s70 offen offset:1280 sc1
    buffer_load_dwordx4 v[180:183], v11, s[44:47], s70 offen offset:1920 sc1
    buffer_load_dwordx4 v[184:187], v11, s[44:47], s71 offen offset:0 sc1
    buffer_load_dwordx4 v[188:191], v11, s[44:47], s71 offen offset:640 sc1
    buffer_load_dwordx4 v[192:195], v11, s[44:47], s71 offen offset:1280 sc1
    buffer_load_dwordx4 v[196:199], v11, s[44:47], s71 offen offset:1920 sc1
    s_waitcnt vmcnt(0)
    v_max3_u32 v12, v72, v73, v74
    v_max3_u32 v12, v12, v75, v76
    v_max3_u32 v12, v12, v77, v78
    v_max3_u32 v12, v12, v79, v80
    v_max3_u32 v12, v12, v81, v82
    v_max3_u32 v12, v12, v83, v84
    v_max3_u32 v12, v12, v85, v86
    v_max3_u32 v12, v12, v87, v88
    v_max3_u32 v12, v12, v89, v90
    v_max3_u32 v12, v12, v91, v92
    v_max3_u32 v12, v12, v93, v94
    v_max3_u32 v12, v12, v95, v96
    v_max3_u32 v12, v12, v97, v98
    v_max3_u32 v12, v12, v99, v100
    v_max3_u32 v12, v12, v101, v102
    v_max3_u32 v12, v12, v103, v104
    v_max3_u32 v12, v12, v105, v106
    v_max3_u32 v12, v12, v107, v108
    v_max3_u32 v12, v12, v109, v110
    v_max3_u32 v12, v12, v111, v112
    v_max3_u32 v12, v12, v113, v114
    v_max3_u32 v12, v12, v115, v116
    v_max3_u32 v12, v12, v117, v118
    v_max3_u32 v12, v12, v119, v120
    v_max3_u32 v12, v12, v121, v122
    v_max3_u32 v12, v12, v123, v124
    v_max3_u32 v12, v12, v125, v126
    v_max3_u32 v12, v12, v127, v128
    v_max3_u32 v12, v12, v129, v130
    v_max3_u32 v12, v12, v131, v132
    v_max3_u32 v12, v12, v133, v134
    v_max3_u32 v12, v12, v135, v136
    v_max3_u32 v12, v12, v137, v138
    v_max3_u32 v12, v12, v139, v140
    v_max3_u32 v12, v12, v141, v142
    v_max3_u32 v12, v12, v143, v144
    v_max3_u32 v12, v12, v145, v146
    v_max3_u32 v12, v12, v147, v148
    v_max3_u32 v12, v12, v149, v150
    v_max3_u32 v12, v12, v151, v152
    v_max3_u32 v12, v12, v153, v154
    v_max3_u32 v12, v12, v155, v156
    v_max3_u32 v12, v12, v157, v158
    v_max3_u32 v12, v12, v159, v160
    v_max3_u32 v12, v12, v161, v162
    v_max3_u32 v12, v12, v163, v164
    v_max3_u32 v12, v12, v165, v166
    v_max3_u32 v12, v12, v167, v168
    v_max3_u32 v12, v12, v169, v170
    v_max3_u32 v12, v12, v171, v172
    v_max3_u32 v12, v12, v173, v174
    v_max3_u32 v12, v12, v175, v176
    v_max3_u32 v12, v12, v177, v178
    v_max3_u32 v12, v12, v179, v180
    v_max3_u32 v12, v12, v181, v182
    v_max3_u32 v12, v12, v183, v184
    v_max3_u32 v12, v12, v185, v186
    v_max3_u32 v12, v12, v187, v188
    v_max3_u32 v12, v12, v189, v190
    v_max3_u32 v12, v12, v191, v192
    v_max3_u32 v12, v12, v193, v194
    v_max3_u32 v12, v12, v195, v196
    v_max3_u32 v12, v12, v197, v198
    v_max_u32 v12, v12, v199
    v_cmp_eq_u32 vcc, -1, v12
    s_cbranch_vccz L_PB_DONE
    s_sub_u32 s58, s58, 1
    s_cmp_eq_u32 s58, 0
    s_cbranch_scc1 L_PB_DONE
    s_sleep 1
    s_branch L_PB_LOOP
L_PB_DONE:
    s_nop 4
    v_add_f32 v72, v72, v76
    v_add_f32 v73, v73, v77
    v_add_f32 v74, v74, v78
    v_add_f32 v75, v75, v79
    v_add_f32 v72, v72, v80
    v_add_f32 v73, v73, v81
    v_add_f32 v74, v74, v82
    v_add_f32 v75, v75, v83
    v_add_f32 v72, v72, v84
    v_add_f32 v73, v73, v85
    v_add_f32 v74, v74, v86
    v_add_f32 v75, v75, v87
    v_add_f32 v72, v72, v88
    v_add_f32 v73, v73, v89
    v_add_f32 v74, v74, v90
    v_add_f32 v75, v75, v91
    v_add_f32 v72, v72, v92
    v_add_f32 v73, v73, v93
    v_add_f32 v74, v74, v94
    v_add_f32 v75, v75, v95
    v_add_f32 v72, v72, v96
    v_add_f32 v73, v73, v97
    v_add_f32 v74, v74, v98
    v_add_f32 v75, v75, v99
    v_add_f32 v72, v72, v100
    v_add_f32 v73, v73, v101
    v_add_f32 v74, v74, v102
    v_add_f32 v75, v75, v103
    v_add_f32 v72, v72, v104
    v_add_f32 v73, v73, v105
    v_add_f32 v74, v74, v106
    v_add_f32 v75, v75, v107
    v_add_f32 v72, v72, v108
    v_add_f32 v73, v73, v109
    v_add_f32 v74, v74, v110
    v_add_f32 v75, v75, v111
    v_add_f32 v72, v72, v112
    v_add_f32 v73, v73, v113
    v_add_f32 v74, v74, v114
    v_add_f32 v75, v75, v115
    v_add_f32 v72, v72, v116
    v_add_f32 v73, v73, v117
    v_add_f32 v74, v74, v118
    v_add_f32 v75, v75, v119
    v_add_f32 v72, v72, v120
    v_add_f32 v73, v73, v121
    v_add_f32 v74, v74, v122
    v_add_f32 v75, v75, v123
    v_add_f32 v72, v72, v124
    v_add_f32 v73, v73, v125
    v_add_f32 v74, v74, v126
    v_add_f32 v75, v75, v127
    v_add_f32 v72, v72, v128
    v_add_f32 v73, v73, v129
    v_add_f32 v74, v74, v130
    v_add_f32 v75, v75, v131
    v_add_f32 v72, v72, v132
    v_add_f32 v73, v73, v133
    v_add_f32 v74, v74, v134
    v_add_f32 v75, v75, v135
    v_add_f32 v72, v72, v136
    v_add_f32 v73, v73, v137
    v_add_f32 v74, v74, v138
    v_add_f32 v75, v75, v139
    v_add_f32 v72, v72, v140
    v_add_f32 v73, v73, v141
    v_add_f32 v74, v74, v142
    v_add_f32 v75, v75, v143
    v_add_f32 v72, v72, v144
    v_add_f32 v73, v73, v145
    v_add_f32 v74, v74, v146
    v_add_f32 v75, v75, v147
    v_add_f32 v72, v72, v148
    v_add_f32 v73, v73, v149
    v_add_f32 v74, v74, v150
    v_add_f32 v75, v75, v151
    v_add_f32 v72, v72, v152
    v_add_f32 v73, v73, v153
    v_add_f32 v74, v74, v154
    v_add_f32 v75, v75, v155
    v_add_f32 v72, v72, v156
    v_add_f32 v73, v73, v157
    v_add_f32 v74, v74, v158
    v_add_f32 v75, v75, v159
    v_add_f32 v72, v72, v160
    v_add_f32 v73, v73, v161
    v_add_f32 v74, v74, v162
    v_add_f32 v75, v75, v163
    v_add_f32 v72, v72, v164
    v_add_f32 v73, v73, v165
    v_add_f32 v74, v74, v166
    v_add_f32 v75, v75, v167
    v_add_f32 v72, v72, v168
    v_add_f32 v73, v73, v169
    v_add_f32 v74, v74, v170
    v_add_f32 v75, v75, v171
    v_add_f32 v72, v72, v172
    v_add_f32 v73, v73, v173
    v_add_f32 v74, v74, v174
    v_add_f32 v75, v75, v175
    v_add_f32 v72, v72, v176
    v_add_f32 v73, v73, v177
    v_add_f32 v74, v74, v178
    v_add_f32 v75, v75, v179
    v_add_f32 v72, v72, v180
    v_add_f32 v73, v73, v181
    v_add_f32 v74, v74, v182
    v_add_f32 v75, v75, v183
    v_add_f32 v72, v72, v184
    v_add_f32 v73, v73, v185
    v_add_f32 v74, v74, v186
    v_add_f32 v75, v75, v187
    v_add_f32 v72, v72, v188
    v_add_f32 v73, v73, v189
    v_add_f32 v74, v74, v190
    v_add_f32 v75, v75, v191
    v_add_f32 v72, v72, v192
    v_add_f32 v73, v73, v193
    v_add_f32 v74, v74, v194
    v_add_f32 v75, v75, v195
    v_add_f32 v72, v72, v196
    v_add_f32 v73, v73, v197
    v_add_f32 v74, v74, v198
    v_add_f32 v75, v75, v199
    v_sub_f32 v14, 1.0, v13
    v_cvt_pk_bf16_f32 v14, v14, 0
    v_lshlrev_b32 v14, 16, v14
    v_cvt_pk_bf16_f32 v72, v72, 0
    v_lshlrev_b32 v72, 16, v72
    v_cvt_pk_bf16_f32 v73, v73, 0
    v_lshlrev_b32 v73, 16, v73
    v_cvt_pk_bf16_f32 v74, v74, 0
    v_lshlrev_b32 v74, 16, v74
    v_cvt_pk_bf16_f32 v75, v75, 0
    v_lshlrev_b32 v75, 16, v75
    v_mul_f32 v72, v13, v72
    v_mul_f32 v73, v13, v73
    v_mul_f32 v74, v14, v74
    v_mul_f32 v75, v14, v75
    v_cvt_pk_bf16_f32 v72, v72, 0
    v_lshlrev_b32 v72, 16, v72
    v_cvt_pk_bf16_f32 v73, v73, 0
    v_lshlrev_b32 v73, 16, v73
    v_cvt_pk_bf16_f32 v74, v74, 0
    v_lshlrev_b32 v74, 16, v74
    v_cvt_pk_bf16_f32 v75, v75, 0
    v_lshlrev_b32 v75, 16, v75
    v_add_f32 v72, v72, v74
    v_add_f32 v73, v73, v75
    v_cvt_pk_bf16_f32 v72, v72, v73
    v_lshlrev_b32 v12, 2, v0
    s_mul_i32 s55, s50, 160
    buffer_store_dword v72, v12, s[36:39], s55 offen sc1
L_FLUSH:
    s_nop 4
L_END:
    s_endpgm
.section .rodata,"a"
.p2align 6
.amdhsa_kernel gated_mix__mha_block_cached__glu_gated_swiglu__decode_kernel
  .amdhsa_next_free_vgpr 240
  .amdhsa_next_free_sgpr 102
  .amdhsa_accum_offset 240
  .amdhsa_group_segment_fixed_size 0
  .amdhsa_kernarg_size 104
  .amdhsa_user_sgpr_count 2
  .amdhsa_user_sgpr_kernarg_segment_ptr 1
  .amdhsa_system_sgpr_workgroup_id_x 1
  .amdhsa_float_denorm_mode_32 3
.end_amdhsa_kernel
```
